```python
import torch

def _softmax(x, axis=-1):
    return torch.softmax(x, dim=axis)
def _gelu(x):
    return torch.nn.functional.gelu(x, approximate="tanh")
def _silu(x):
    return torch.nn.functional.silu(x)
def _sigmoid(x):
    return torch.sigmoid(x)
def _layernorm(x, axis=-1, eps=1e-5):
    m = x.mean(dim=axis, keepdim=True)
    v = x.var(dim=axis, keepdim=True, unbiased=False)
    return (x - m) / torch.sqrt(v + eps)
def _scatter_add(tgt, idx, src, axis=0):
    return tgt.clone().index_add_(axis, idx, src)
def _segment_sum(src, seg, n):
    out = torch.zeros((n,) + src.shape[1:], dtype=src.dtype)
    return out.index_add_(0, seg, src)
def _pad(x, pw):
    flat = tuple(v for pair in reversed(pw) for v in pair)
    return torch.nn.functional.pad(x, flat)

kernel_name = 'sequential_preLN__grouped_kv_mqa__mixer_channel_mlp__prompt'

def setup_inputs():

    _w = (lambda a: (lambda t: t.to(torch.bfloat16) if t.is_floating_point() else t)(torch.as_tensor(a)))
    def _A_setup():
        B, S, D, H = 1, 2048, 576, 32
        Dh = D // H
        return {
            "x": _w((lambda *s: torch.randn(*s, dtype=torch.bfloat16) * 0.05)(B, S, D)),
            "wq": _w((lambda *s: torch.randn(*s, dtype=torch.bfloat16) * 0.05)(D, H * Dh)),
            "wk": _w((lambda *s: torch.randn(*s, dtype=torch.bfloat16) * 0.05)(D, Dh)),
            "wv": _w((lambda *s: torch.randn(*s, dtype=torch.bfloat16) * 0.05)(D, Dh)),
            "wo": _w((lambda *s: torch.randn(*s, dtype=torch.bfloat16) * 0.05)(H * Dh, D)),
        }
    _A_in = _A_setup()

    def _B_setup():
        B, S, D, F = 1, 2048, 576, 4608
        return {
            "x": _w((lambda *s: torch.randn(*s, dtype=torch.bfloat16) * 0.05)(B, S, D)),
            "w1": _w((lambda *s: torch.randn(*s, dtype=torch.bfloat16) * 3.2)(D, F) * (D ** -0.5)),
            "b1": _w((lambda *s: torch.randn(*s, dtype=torch.bfloat16) * 1.6)(F)),
            "w2": _w((lambda *s: torch.randn(*s, dtype=torch.bfloat16) * 0.1)(F, D) * (F ** -0.5)),
            "b2": _w((lambda *s: torch.randn(*s, dtype=torch.bfloat16) * 0.2)(D)),
        }
    _B_in = _B_setup()

    return {
        "A_x": _A_in["x"],
        "A_wq": _A_in["wq"],
        "A_wk": _A_in["wk"],
        "A_wv": _A_in["wv"],
        "A_wo": _A_in["wo"],
        "B_x": _B_in["x"],
        "B_w1": _B_in["w1"],
        "B_b1": _B_in["b1"],
        "B_w2": _B_in["w2"],
        "B_b2": _B_in["b2"],
    }

def reference(A_x, A_wq, A_wk, A_wv, A_wo, B_x, B_w1, B_b1, B_w2, B_b2):
    def _A_ref(x, wq, wk, wv, wo):
        B, S, D = x.shape
        H = 32
        Dh = D // H
        q = (lambda x, *d: x.permute(*d))((x @ wq).reshape(B, S, H, Dh), 0, 2, 1, 3)
        k = x @ wk
        v = x @ wv
        scores = torch.einsum("bhqd,bkd->bhqk", q, k) * (Dh ** -0.5)
        p = _softmax(scores, axis=-1)
        o = torch.einsum("bhqk,bkd->bhqd", p, v)
        return (lambda x, *d: x.permute(*d))(o, 0, 2, 1, 3).reshape(B, S, H * Dh) @ wo

    def _B_ref(x, w1, b1, w2, b2):
        y = _layernorm(x, axis=-1)
        h = _gelu(torch.einsum("bsd,df->bsf", y, w1) + b1)
        return torch.einsum("bsf,fd->bsd", h, w2) + b2

    x = A_x
    h = x + _A_ref(_layernorm(x, axis=-1), A_wq, A_wk, A_wv, A_wo)
    h2 = h + _B_ref(_layernorm(h, axis=-1), B_w1, B_b1, B_w2, B_b2)
    return h2
```

```asm
; @launch grid=(256,1,1) block=(512,1,1) lds=163840
.amdgcn_target "amdgcn-amd-amdhsa--gfx950"
.text
.p2align 8
.globl sequential_preLN__grouped_kv_mqa__mixer_channel_mlp__prompt_kernel
.type sequential_preLN__grouped_kv_mqa__mixer_channel_mlp__prompt_kernel,@function
sequential_preLN__grouped_kv_mqa__mixer_channel_mlp__prompt_kernel:
    s_cmp_ge_u32 s2, 256
    s_cbranch_scc1 L_end
    s_load_dwordx8 s[4:11], s[0:1], 0
    s_load_dwordx4 s[12:15], s[0:1], 88
    s_load_dwordx2 s[28:29], s[0:1], 32
    v_and_b32 v1, 63, v0
    v_lshrrev_b32 v7, 6, v0
    s_nop 0
    v_readfirstlane_b32 s3, v7
    s_nop 0
    s_xor_b32 s3, s3, 4
    s_and_b32 s40, s2, 31
    s_lshr_b32 s41, s2, 5
    s_movk_i32 s44, 1152
    s_lshl_b32 s42, s40, 6
    s_and_b32 s43, s3, 3
    v_lshlrev_b32 v6, 4, v1
    v_lshrrev_b32 v10, 4, v1
    v_and_b32 v11, 15, v1
    s_cmp_lt_u32 s3, 4
    s_cbranch_scc1 L_q_compute
    v_lshrrev_b32 v8, 3, v1
    v_and_b32 v9, 7, v1
    v_xor_b32 v12, v9, v8
    v_lshlrev_b32 v12, 4, v12
    v_mad_u32_u24 v12, v8, s44, v12
    v_and_b32 v13, 2, v8
    v_xor_b32 v13, v9, v13
    v_lshlrev_b32 v13, 4, v13
    v_mad_u32_u24 v13, v8, s44, v13
    v_xor_b32 v14, 64, v13
    v_add_u32 v14, 9216, v14
    s_lshr_b32 s45, s40, 3
    s_add_u32 s60, s45, s41
    s_lshl_b32 s45, s43, 4
    s_add_u32 s46, s42, s45
    s_mul_i32 s46, s46, 1152
    s_mul_i32 s47, s43, 36864
    s_lshl_b32 s48, s41, 7
    s_add_u32 s47, s47, s48
    s_lshl_b32 s50, s43, 11
    s_mul_i32 s51, s43, 5120
    s_add_u32 s51, s51, 73728
    s_waitcnt lgkmcnt(0)
    s_mov_b32 s16, s4
    s_and_b32 s17, s5, 0xffff
    s_mov_b32 s18, 2359296
    s_mov_b32 s19, 0x00020000
    s_mov_b32 s20, s6
    s_and_b32 s21, s7, 0xffff
    s_mov_b32 s22, 663552
    s_mov_b32 s23, 0x00020000
    s_add_u32 s61, s60, 0
    s_and_b32 s61, s61, 3
    s_lshl_b32 s62, s61, 8
    s_add_u32 s62, s62, s46
    s_mul_i32 s63, s61, 147456
    s_add_u32 s63, s63, s47
    s_add_u32 s64, s62, 9216
    s_add_u32 m0, s50, 0
    s_nop 0
    buffer_load_dwordx4 v12, s[16:19], s62 offen offset:0 lds
    s_add_u32 m0, s50, 1024
    s_nop 0
    buffer_load_dwordx4 v12, s[16:19], s64 offen offset:0 lds
    s_add_u32 m0, s51, 0
    s_nop 0
    buffer_load_dwordx4 v13, s[20:23], s63 offen lds
    s_add_u32 m0, s51, 1024
    s_nop 0
    buffer_load_dwordx4 v14, s[20:23], s63 offen lds
    s_add_u32 m0, s51, 2048
    s_add_u32 s63, s63, 18432
    buffer_load_dwordx4 v13, s[20:23], s63 offen lds
    s_add_u32 m0, s51, 3072
    s_nop 0
    buffer_load_dwordx4 v14, s[20:23], s63 offen lds
    s_cmp_lt_u32 s41, 6
    s_cselect_b32 s24, s8, s10
    s_cselect_b32 s25, s9, s11
    s_cmp_lt_u32 s41, 4
    s_cselect_b32 s24, s6, s24
    s_cselect_b32 s25, s7, s25
    s_mov_b32 s26, 20736
    s_cmov_b32 s26, 663552
    s_mov_b32 s54, 36
    s_cmov_b32 s54, 1152
    s_lshl_b32 s55, s41, 5
    s_add_u32 s56, s55, 1024
    s_and_b32 s55, s55, 32
    s_cmp_lt_u32 s41, 4
    s_cselect_b32 s55, s56, s55
    s_and_b32 s25, s25, 0xffff
    s_mov_b32 s27, 0x00020000
    s_lshl_b32 s56, s43, 5
    s_mul_i32 s56, s56, s54
    s_add_u32 s55, s55, s56
    s_lshl_b32 s56, s54, 7
    v_lshrrev_b32 v8, 1, v1
    v_lshrrev_b32 v9, 2, v1
    v_and_b32 v9, 4, v9
    v_xor_b32 v8, v8, v9
    v_and_b32 v9, 1, v1
    v_lshlrev_b32 v9, 4, v9
    v_mad_u32_u24 v15, v8, s54, v9
    s_mul_i32 s65, s61, s56
    s_add_u32 s65, s65, s55
    s_add_u32 m0, s51, 4096
    s_nop 0
    buffer_load_dwordx4 v15, s[24:27], s65 offen lds
    s_add_u32 m0, s50, 8064
    s_nop 0
    buffer_load_dwordx4 v12, s[16:19], s62 offen offset:128 lds
    s_add_u32 m0, s50, 9088
    s_nop 0
    buffer_load_dwordx4 v12, s[16:19], s64 offen offset:128 lds
    v_bfe_u32 v16, v1, 2, 2
    v_lshl_add_u32 v17, v10, 3, v16
    v_lshrrev_b32 v18, 1, v16
    v_and_b32 v19, 1, v10
    v_lshl_add_u32 v18, v19, 1, v18
    v_xor_b32 v18, s43, v18
    v_lshlrev_b32 v18, 5, v18
    v_lshl_add_u32 v2, v17, 7, v18
    v_and_b32 v18, 3, v1
    v_lshl_add_u32 v2, v18, 3, v2
    v_add_u32 v2, 73728, v2
    v_xor_b32 v3, 32, v2
    v_lshlrev_b32 v19, 2, v19
    v_xor_b32 v17, v17, v19
    v_lshlrev_b32 v4, 5, v17
    v_lshl_add_u32 v4, v18, 3, v4
    v_add_u32 v4, 77824, v4
    v_xor_b32 v5, 128, v4
    s_mul_i32 s45, s43, 5120
    v_add_u32 v4, s45, v4
    v_add_u32 v5, s45, v5
    v_mov_b32 v100, 0x3f803f80
    v_mov_b32 v101, 0x3f803f80
    v_mov_b32 v102, 0x3f803f80
    v_mov_b32 v103, 0x3f803f80
    s_mov_b32 s32, s14
    s_and_b32 s33, s15, 0xffff
    s_mov_b32 s34, 35782656
    s_mov_b32 s35, 0x00020000
    s_add_u32 s61, s60, 1
    s_and_b32 s61, s61, 3
    s_lshl_b32 s62, s61, 8
    s_add_u32 s62, s62, s46
    s_mul_i32 s63, s61, 147456
    s_add_u32 s63, s63, s47
    s_add_u32 s64, s62, 9216
    s_add_u32 m0, s50, 16384
    s_nop 0
    buffer_load_dwordx4 v12, s[16:19], s62 offen offset:0 lds
    s_add_u32 m0, s50, 17408
    s_nop 0
    buffer_load_dwordx4 v12, s[16:19], s64 offen offset:0 lds
    s_add_u32 m0, s51, 20480
    s_nop 0
    buffer_load_dwordx4 v13, s[20:23], s63 offen lds
    s_add_u32 m0, s51, 21504
    s_nop 0
    buffer_load_dwordx4 v14, s[20:23], s63 offen lds
    s_add_u32 m0, s51, 22528
    s_add_u32 s63, s63, 18432
    buffer_load_dwordx4 v13, s[20:23], s63 offen lds
    s_add_u32 m0, s51, 23552
    s_nop 0
    buffer_load_dwordx4 v14, s[20:23], s63 offen lds
    s_mul_i32 s65, s61, s56
    s_add_u32 s65, s65, s55
    s_add_u32 m0, s51, 24576
    s_nop 0
    buffer_load_dwordx4 v15, s[24:27], s65 offen lds
    s_add_u32 m0, s50, 24448
    s_nop 0
    buffer_load_dwordx4 v12, s[16:19], s62 offen offset:128 lds
    s_add_u32 m0, s50, 25472
    s_nop 0
    buffer_load_dwordx4 v12, s[16:19], s64 offen offset:128 lds
    s_waitcnt vmcnt(9)
    s_barrier
    ds_read_b64_tr_b16 v[24:25], v2 offset:0
    ds_read_b64_tr_b16 v[26:27], v2 offset:512
    ds_read_b64_tr_b16 v[28:29], v2 offset:5120
    ds_read_b64_tr_b16 v[30:31], v2 offset:5632
    ds_read_b64_tr_b16 v[32:33], v2 offset:10240
    ds_read_b64_tr_b16 v[34:35], v2 offset:10752
    ds_read_b64_tr_b16 v[36:37], v2 offset:15360
    ds_read_b64_tr_b16 v[38:39], v2 offset:15872
    ds_read_b64_tr_b16 v[40:41], v4 offset:0
    ds_read_b64_tr_b16 v[42:43], v5 offset:0
    s_add_u32 s61, s60, 2
    s_and_b32 s61, s61, 3
    s_lshl_b32 s62, s61, 8
    s_add_u32 s62, s62, s46
    s_mul_i32 s63, s61, 147456
    s_add_u32 s63, s63, s47
    s_add_u32 s64, s62, 9216
    s_add_u32 m0, s50, 32768
    s_nop 0
    buffer_load_dwordx4 v12, s[16:19], s62 offen offset:0 lds
    s_add_u32 m0, s50, 33792
    s_nop 0
    buffer_load_dwordx4 v12, s[16:19], s64 offen offset:0 lds
    s_add_u32 m0, s51, 40960
    s_nop 0
    buffer_load_dwordx4 v13, s[20:23], s63 offen lds
    s_add_u32 m0, s51, 41984
    s_nop 0
    buffer_load_dwordx4 v14, s[20:23], s63 offen lds
    s_add_u32 m0, s51, 43008
    s_add_u32 s63, s63, 18432
    buffer_load_dwordx4 v13, s[20:23], s63 offen lds
    s_add_u32 m0, s51, 44032
    s_nop 0
    buffer_load_dwordx4 v14, s[20:23], s63 offen lds
    s_mul_i32 s65, s61, s56
    s_add_u32 s65, s65, s55
    s_add_u32 m0, s51, 45056
    s_nop 0
    buffer_load_dwordx4 v15, s[24:27], s65 offen lds
    s_add_u32 m0, s50, 40832
    s_nop 0
    buffer_load_dwordx4 v12, s[16:19], s62 offen offset:128 lds
    s_add_u32 m0, s50, 41856
    s_nop 0
    buffer_load_dwordx4 v12, s[16:19], s64 offen offset:128 lds
    s_waitcnt lgkmcnt(0)
    v_mfma_f32_16x16x32_bf16 v[92:95], v[24:27], v[100:103], 0
    v_mfma_f32_16x16x32_bf16 v[92:95], v[28:31], v[100:103], v[92:95]
    v_mfma_f32_16x16x32_bf16 v[92:95], v[32:35], v[100:103], v[92:95]
    v_mfma_f32_16x16x32_bf16 v[92:95], v[36:39], v[100:103], v[92:95]
    v_mfma_f32_16x16x32_bf16 v[96:99], v[40:43], v[100:103], 0
    s_waitcnt vmcnt(9)
    s_barrier
    ds_read_b64_tr_b16 v[44:45], v2 offset:20480
    ds_read_b64_tr_b16 v[46:47], v2 offset:20992
    ds_read_b64_tr_b16 v[48:49], v2 offset:25600
    ds_read_b64_tr_b16 v[50:51], v2 offset:26112
    ds_read_b64_tr_b16 v[52:53], v2 offset:30720
    ds_read_b64_tr_b16 v[54:55], v2 offset:31232
    ds_read_b64_tr_b16 v[56:57], v2 offset:35840
    ds_read_b64_tr_b16 v[58:59], v2 offset:36352
    ds_read_b64_tr_b16 v[60:61], v4 offset:20480
    ds_read_b64_tr_b16 v[62:63], v5 offset:20480
    s_add_u32 s61, s60, 3
    s_and_b32 s61, s61, 3
    s_lshl_b32 s62, s61, 8
    s_add_u32 s62, s62, s46
    s_mul_i32 s63, s61, 147456
    s_add_u32 s63, s63, s47
    s_add_u32 s64, s62, 9216
    s_add_u32 m0, s50, 49152
    s_nop 0
    buffer_load_dwordx4 v12, s[16:19], s62 offen offset:0 lds
    s_add_u32 m0, s50, 50176
    s_nop 0
    buffer_load_dwordx4 v12, s[16:19], s64 offen offset:0 lds
    s_add_u32 m0, s51, 61440
    s_nop 0
    buffer_load_dwordx4 v13, s[20:23], s63 offen lds
    s_add_u32 m0, s51, 62464
    s_nop 0
    buffer_load_dwordx4 v14, s[20:23], s63 offen lds
    s_add_u32 m0, s51, 63488
    s_add_u32 s63, s63, 18432
    buffer_load_dwordx4 v13, s[20:23], s63 offen lds
    s_add_u32 m0, s51, 64512
    s_nop 0
    buffer_load_dwordx4 v14, s[20:23], s63 offen lds
    s_mul_i32 s65, s61, s56
    s_add_u32 s65, s65, s55
    s_add_u32 m0, s51, 65536
    s_nop 0
    buffer_load_dwordx4 v15, s[24:27], s65 offen lds
    s_add_u32 m0, s50, 57216
    s_nop 0
    buffer_load_dwordx4 v12, s[16:19], s62 offen offset:128 lds
    s_add_u32 m0, s50, 58240
    s_nop 0
    buffer_load_dwordx4 v12, s[16:19], s64 offen offset:128 lds
    s_waitcnt lgkmcnt(0)
    v_mfma_f32_16x16x32_bf16 v[92:95], v[44:47], v[100:103], v[92:95]
    v_mfma_f32_16x16x32_bf16 v[92:95], v[48:51], v[100:103], v[92:95]
    v_mfma_f32_16x16x32_bf16 v[92:95], v[52:55], v[100:103], v[92:95]
    v_mfma_f32_16x16x32_bf16 v[92:95], v[56:59], v[100:103], v[92:95]
    v_mfma_f32_16x16x32_bf16 v[96:99], v[60:63], v[100:103], v[96:99]
    s_waitcnt vmcnt(9)
    s_barrier
    ds_read_b64_tr_b16 v[24:25], v2 offset:40960
    ds_read_b64_tr_b16 v[26:27], v2 offset:41472
    ds_read_b64_tr_b16 v[28:29], v2 offset:46080
    ds_read_b64_tr_b16 v[30:31], v2 offset:46592
    ds_read_b64_tr_b16 v[32:33], v2 offset:51200
    ds_read_b64_tr_b16 v[34:35], v2 offset:51712
    ds_read_b64_tr_b16 v[36:37], v2 offset:56320
    ds_read_b64_tr_b16 v[38:39], v2 offset:56832
    ds_read_b64_tr_b16 v[40:41], v4 offset:40960
    ds_read_b64_tr_b16 v[42:43], v5 offset:40960
    s_mov_b32 s61, 4
    s_lshl_b32 s62, s61, 8
    s_add_u32 s62, s62, s46
    s_mul_i32 s63, s61, 147456
    s_add_u32 s63, s63, s47
    s_add_u32 s64, s62, 9216
    s_add_u32 m0, s50, 65536
    s_nop 0
    buffer_load_dwordx4 v12, s[16:19], s62 offen offset:0 lds
    s_add_u32 m0, s50, 66560
    s_nop 0
    buffer_load_dwordx4 v12, s[16:19], s64 offen offset:0 lds
    s_cmp_lg_u32 s43, 0
    s_cbranch_scc1 L_q_g17
    s_add_u32 m0, s51, 81920
    s_nop 0
    buffer_load_dwordx4 v13, s[20:23], s63 offen lds
    s_add_u32 m0, s51, 82944
    s_nop 0
    buffer_load_dwordx4 v14, s[20:23], s63 offen lds
    s_add_u32 m0, s51, 83968
    s_add_u32 s63, s63, 18432
    buffer_load_dwordx4 v13, s[20:23], s63 offen lds
    s_add_u32 m0, s51, 84992
    s_nop 0
    buffer_load_dwordx4 v14, s[20:23], s63 offen lds
    s_mul_i32 s65, s61, s56
    s_add_u32 s65, s65, s55
    s_add_u32 m0, s51, 86016
    s_nop 0
    buffer_load_dwordx4 v15, s[24:27], s65 offen lds
    s_branch L_q_issued
L_q_g17:
    buffer_load_dwordx4 v[104:107], v13, s[20:23], s63 offen
    buffer_load_dwordx4 v[108:111], v14, s[20:23], s63 offen
    s_add_u32 s63, s63, 18432
    buffer_load_dwordx4 v[112:115], v13, s[20:23], s63 offen
    buffer_load_dwordx4 v[116:119], v14, s[20:23], s63 offen
    s_mul_i32 s65, s61, s56
    s_add_u32 s65, s65, s55
    buffer_load_dwordx4 v[120:123], v15, s[24:27], s65 offen
L_q_issued:
    s_waitcnt lgkmcnt(0)
    v_mfma_f32_16x16x32_bf16 v[92:95], v[24:27], v[100:103], v[92:95]
    v_mfma_f32_16x16x32_bf16 v[92:95], v[28:31], v[100:103], v[92:95]
    v_mfma_f32_16x16x32_bf16 v[92:95], v[32:35], v[100:103], v[92:95]
    v_mfma_f32_16x16x32_bf16 v[92:95], v[36:39], v[100:103], v[92:95]
    v_mfma_f32_16x16x32_bf16 v[96:99], v[40:43], v[100:103], v[96:99]
    s_waitcnt vmcnt(7)
    s_barrier
    v_add_u32 v2, 61440, v2
    v_add_u32 v4, 61440, v4
    v_add_u32 v5, 61440, v5
    ds_read_b64_tr_b16 v[44:45], v2 offset:0
    ds_read_b64_tr_b16 v[46:47], v2 offset:512
    ds_read_b64_tr_b16 v[48:49], v2 offset:5120
    ds_read_b64_tr_b16 v[50:51], v2 offset:5632
    ds_read_b64_tr_b16 v[52:53], v2 offset:10240
    ds_read_b64_tr_b16 v[54:55], v2 offset:10752
    ds_read_b64_tr_b16 v[56:57], v2 offset:15360
    ds_read_b64_tr_b16 v[58:59], v2 offset:15872
    ds_read_b64_tr_b16 v[60:61], v4 offset:0
    ds_read_b64_tr_b16 v[62:63], v5 offset:0
    v_mov_b32 v8, 0
    s_mov_b32 s45, 153600
    buffer_load_dword v136, v8, s[32:35], s45 offen sc1
    s_waitcnt vmcnt(1)
    s_cmp_lg_u32 s43, 1
    s_cbranch_scc1 L_q_nog17
    v_add_u32 v9, 73728, v6
    ds_write_b128 v9, v[104:107] offset:0
    ds_write_b128 v9, v[108:111] offset:1024
    ds_write_b128 v9, v[112:115] offset:2048
    ds_write_b128 v9, v[116:119] offset:3072
    ds_write_b128 v9, v[120:123] offset:4096
L_q_nog17:
    v_mov_b64 v[144:145], -1
    v_mov_b64 v[146:147], -1
    s_mul_i32 s45, s2, 9216
    s_lshl_b32 s49, s43, 11
    s_add_u32 s45, s45, s49
    s_add_u32 s45, s45, 3407872
    buffer_store_dwordx4 v[144:147], v6, s[32:35], s45 offen offset:0 sc1
    buffer_store_dwordx4 v[144:147], v6, s[32:35], s45 offen offset:1024 sc1
    buffer_store_dwordx4 v[144:147], v6, s[32:35], s45 offen offset:2048 sc1
    s_waitcnt lgkmcnt(0)
    v_mfma_f32_16x16x32_bf16 v[92:95], v[44:47], v[100:103], v[92:95]
    v_mfma_f32_16x16x32_bf16 v[92:95], v[48:51], v[100:103], v[92:95]
    v_mfma_f32_16x16x32_bf16 v[92:95], v[52:55], v[100:103], v[92:95]
    v_mfma_f32_16x16x32_bf16 v[92:95], v[56:59], v[100:103], v[92:95]
    v_mfma_f32_16x16x32_bf16 v[96:99], v[60:63], v[100:103], v[96:99]
    s_barrier
    ds_read_b64_tr_b16 v[24:25], v2 offset:20480
    ds_read_b64_tr_b16 v[26:27], v2 offset:20992
    v_subrev_u32 v2, 61440, v2
    ds_read_b64_tr_b16 v[28:29], v2
    ds_read_b64_tr_b16 v[30:31], v2 offset:512
    s_cmp_eq_u32 s43, 1
    s_mov_b32 s45, 20480
    s_cmov_b32 s45, 4294900736
    s_cmp_ge_u32 s43, 2
    s_cmov_b32 s45, 0x100000
    v_add_u32 v4, s45, v4
    v_add_u32 v5, s45, v5
    ds_read_b64_tr_b16 v[40:41], v4
    ds_read_b64_tr_b16 v[42:43], v5
    s_waitcnt lgkmcnt(0)
    v_mfma_f32_16x16x32_bf16 v[92:95], v[24:27], v[100:103], v[92:95]
    v_mfma_f32_16x16x32_bf16 v[92:95], v[28:31], v[100:103], v[92:95]
    v_mfma_f32_16x16x32_bf16 v[96:99], v[40:43], v[100:103], v[96:99]
    s_lshl_b32 s45, s43, 7
    s_add_u32 s45, s45, 160768
    v_lshl_add_u32 v12, v10, 4, s45
    s_mov_b32 s60, 0x00010001
    s_mov_b32 s61, 0x00010001
    s_mov_b64 exec, s[60:61]
    s_nop 0
    ds_write_b128 v12, v[92:95]
    ds_write_b128 v12, v[96:99] offset:64
    s_mov_b64 exec, -1
    s_waitcnt lgkmcnt(0)
    s_barrier
    s_waitcnt vmcnt(3)
    s_mov_b32 s45, 1664525
    v_mul_lo_u32 v136, v136, s45
    v_add_u32 v136, 1013904223, v136
    v_mov_b32 v9, 161792
    ds_write_b32 v9, v136
    s_mul_i32 s45, s43, 2304
    v_lshrrev_b32 v16, 3, v1
    v_and_b32 v17, 7, v1
    v_lshlrev_b32 v17, 4, v17
    v_mul_u32_u24 v18, 144, v16
    v_add3_u32 v18, v18, v17, s45
    v_mad_u32_u24 v17, v16, s44, v17
    s_add_u32 s46, s46, s48
    s_add_u32 s46, s46, 1048576
    s_add_u32 s47, s46, 9216
    s_barrier
    ds_read_b128 v[148:151], v18
    ds_read_b128 v[152:155], v18 offset:1152
    s_waitcnt lgkmcnt(1)
    buffer_store_dwordx4 v[148:151], v17, s[32:35], s46 offen sc1
    s_waitcnt lgkmcnt(0)
    buffer_store_dwordx4 v[152:155], v17, s[32:35], s47 offen sc1
    s_branch L_q_fin
L_q_compute:
    s_getpc_b64 s[66:67]
L_q_pc2:
    s_sub_u32 s66, s66, L_q_pc2 - sequential_preLN__grouped_kv_mqa__mixer_channel_mlp__prompt_kernel
    s_subb_u32 s67, s67, 0
    s_bfe_u32 s45, s2, 0x20003
    s_lshl_b32 s45, s45, 2
    s_add_u32 s45, s45, s43
    s_min_u32 s45, s45, 8
    s_lshl_b32 s45, s45, 12
    v_lshlrev_b32 v2, 6, v1
    v_add_u32 v2, s45, v2
    global_load_dword v124, v2, s[66:67]
    s_waitcnt lgkmcnt(0)
    s_mov_b32 s32, s14
    s_and_b32 s33, s15, 0xffff
    s_mov_b32 s34, 35782656
    s_mov_b32 s35, 0x00020000
    s_lshl_b32 s45, s43, 4
    s_add_u32 s45, s45, s42
    v_add_u32 v2, s45, v11
    v_mul_u32_u24 v2, 1152, v2
    s_lshl_b32 s46, s41, 7
    s_add_u32 s46, s46, 1048576
    v_add_u32 v3, s46, v2
    v_add_u32 v2, 1049600, v2
    v_cmp_eq_u32 vcc, 0, v10
    s_mul_i32 s46, s2, 640
    s_nop 0
    v_cndmask_b32 v2, v2, v3, vcc
    v_lshl_add_u32 v3, v11, 6, s46
    v_cmp_eq_u32 vcc, 2, v10
    s_mul_i32 s46, s2, 640
    s_add_u32 s46, s46, 851968
    v_cndmask_b32 v2, v2, v3, vcc
    v_lshl_add_u32 v3, v11, 6, s46
    v_cmp_eq_u32 vcc, 3, v10
    s_cmp_eq_u32 s41, 0
    s_cselect_b32 s46, 0xffff0000, 1
    s_cmp_eq_u32 s43, 0
    s_cselect_b32 s47, 0x03ff03ff, 0
    v_cndmask_b32 v2, v2, v3, vcc
    s_mov_b64 exec, s[46:47]
    buffer_load_dword v126, v2, s[32:35], 0 offen sc1
    s_mov_b64 exec, -1
    s_mov_b32 s36, s28
    s_and_b32 s37, s29, 0xffff
    s_mov_b32 s38, 663552
    s_mov_b32 s39, 0x00020000
    s_lshl_b32 s57, s43, 8
    s_add_u32 s57, s57, s2
    s_cmp_ge_u32 s57, 648
    s_cbranch_scc1 L_q_nowo
    s_mov_b32 s75, 119304648
    s_mul_hi_u32 s71, s57, s75
    s_mul_i32 s75, s71, 36
    s_sub_u32 s72, s57, s75
    s_mov_b32 s75, 477218589
    s_mul_hi_u32 s73, s71, s75
    s_mul_i32 s75, s73, 9
    s_sub_u32 s74, s71, s75
    s_mov_b32 s75, 477218589
    s_mul_hi_u32 s78, s72, s75
    s_mul_i32 s75, s78, 9
    s_sub_u32 s79, s72, s75
    s_lshl_b32 s58, s57, 10
    s_add_u32 s58, s58, 184320
    v_and_b32 v16, 15, v1
    v_and_b32 v17, 12, v1
    v_add_u32 v17, v16, v17
    s_cmp_lt_u32 s79, 8
    s_cselect_b64 vcc, -1, 0
    v_cndmask_b32 v7, v16, v17, vcc
    v_lshlrev_b32 v7, 1, v7
    s_lshr_b32 s75, s79, 1
    s_lshl_b32 s75, s75, 5
    s_and_b32 s79, s79, 1
    s_lshl_b32 s79, s79, 2
    s_add_u32 s79, s79, s75
    s_mul_i32 s78, s78, 144
    s_add_u32 s79, s79, s78
    s_lshl_b32 s79, s79, 1
    v_lshrrev_b32 v16, 4, v1
    v_lshrrev_b32 v17, 1, v16
    v_mul_u32_u24 v17, 18, v17
    v_and_b32 v18, 1, v16
    v_lshl_add_u32 v17, v18, 3, v17
    v_mul_u32_u24 v18, 72, v16
    s_cmp_lt_u32 s74, 8
    s_cselect_b64 vcc, -1, 0
    s_mov_b32 s76, 20736
    s_cmov_b32 s76, 2304
    s_mul_i32 s75, s74, 36
    s_cselect_b32 s77, s75, 16
    v_cndmask_b32 v17, v18, v17, vcc
    s_mul_i32 s75, s73, 288
    s_add_u32 s77, s77, s75
    s_mul_i32 s77, s77, 1152
    s_add_u32 s77, s77, s79
    s_movk_i32 s75, 1152
    v_mad_u32_u24 v7, v17, s75, v7
    buffer_load_ushort v128, v7, s[36:39], s77 offen
    buffer_load_ushort v129, v7, s[36:39], s77 offen offset:1152
    s_add_u32 s77, s77, s76
    buffer_load_ushort v130, v7, s[36:39], s77 offen
    buffer_load_ushort v131, v7, s[36:39], s77 offen offset:1152
    s_add_u32 s77, s77, s76
    buffer_load_ushort v132, v7, s[36:39], s77 offen
    buffer_load_ushort v133, v7, s[36:39], s77 offen offset:1152
    s_add_u32 s77, s77, s76
    buffer_load_ushort v134, v7, s[36:39], s77 offen
    buffer_load_ushort v135, v7, s[36:39], s77 offen offset:1152
    s_add_u32 s77, s77, s76
L_q_nowo:
    v_and_b32 v12, 7, v1
    v_xor_b32 v12, v10, v12
    v_lshlrev_b32 v12, 4, v12
    v_lshl_add_u32 v7, v11, 7, v12
    s_lshl_b32 s45, s43, 11
    v_add_u32 v7, s45, v7
    v_xor_b32 v8, 64, v7
    v_xor_b32 v14, 2048, v7
    v_xor_b32 v15, 2048, v8
    s_and_b32 s48, s43, 1
    s_lshl_b32 s48, s48, 1
    v_bfe_u32 v16, v1, 2, 2
    v_lshl_add_u32 v17, v10, 3, v16
    v_lshrrev_b32 v18, 1, v16
    v_and_b32 v19, 1, v10
    v_lshl_add_u32 v18, v19, 1, v18
    v_xor_b32 v18, s48, v18
    v_lshlrev_b32 v18, 5, v18
    v_lshl_add_u32 v2, v17, 7, v18
    v_and_b32 v18, 3, v1
    v_lshl_add_u32 v2, v18, 3, v2
    v_add_u32 v2, 73728, v2
    v_xor_b32 v3, 32, v2
    v_lshlrev_b32 v19, 2, v19
    v_xor_b32 v17, v17, v19
    v_lshlrev_b32 v4, 5, v17
    v_lshl_add_u32 v4, v18, 3, v4
    v_add_u32 v4, 77824, v4
    v_xor_b32 v5, 128, v4
    v_mov_b32 v100, 0x3f803f80
    v_mov_b32 v101, 0x3f803f80
    v_mov_b32 v102, 0x3f803f80
    v_mov_b32 v103, 0x3f803f80
    s_lshl_b32 s45, s43, 4
    s_add_u32 s42, s42, s45
    v_add_u32 v9, s42, v11
    v_lshlrev_b32 v12, 4, v10
    v_add_u32 v12, 160768, v12
    s_lshl_b32 s46, s48, 7
    v_add_u32 v122, s46, v12
    v_and_b32 v16, 3, v1
    v_cmp_eq_u32 s[60:61], 1, v16
    v_cmp_eq_u32 s[62:63], 2, v16
    v_cmp_eq_u32 s[64:65], 3, v16
    v_bfe_u32 v17, v1, 2, 2
    v_cmp_eq_u32 s[68:69], v17, v10
    s_lshl_b32 s46, s43, 7
    s_add_u32 s46, s46, 161280
    v_lshl_add_u32 v13, v11, 3, s46
    v_xor_b32 v123, 128, v13
    s_mul_i32 s45, s43, 2304
    s_lshl_b32 s46, s48, 5
    v_mul_u32_u24 v16, 144, v11
    v_lshl_add_u32 v16, v10, 3, v16
    v_add3_u32 v120, v16, s46, 0
    s_xor_b32 s46, s43, 1
    s_mul_i32 s46, s46, 2304
    v_add_u32 v121, s46, v120
    v_add_u32 v120, s45, v120
    s_barrier
    ds_read_b128 v[144:147], v7 offset:0
    ds_read_b64_tr_b16 v[160:161], v4 offset:0
    ds_read_b64_tr_b16 v[162:163], v5 offset:0
    ds_read_b128 v[148:151], v14 offset:0
    ds_read_b64_tr_b16 v[152:153], v2 offset:0
    ds_read_b64_tr_b16 v[154:155], v2 offset:512
    ds_read_b64_tr_b16 v[156:157], v3 offset:0
    ds_read_b64_tr_b16 v[158:159], v3 offset:512
    s_waitcnt lgkmcnt(7)
    ds_read_b128 v[164:167], v8 offset:0
    ds_read_b64_tr_b16 v[180:181], v4 offset:5120
    ds_read_b64_tr_b16 v[182:183], v5 offset:5120
    ds_read_b128 v[168:171], v15 offset:0
    ds_read_b64_tr_b16 v[172:173], v2 offset:5120
    ds_read_b64_tr_b16 v[174:175], v2 offset:5632
    ds_read_b64_tr_b16 v[176:177], v3 offset:5120
    ds_read_b64_tr_b16 v[178:179], v3 offset:5632
    s_waitcnt lgkmcnt(8)
    v_mfma_f32_16x16x32_bf16 v[84:87], v[100:103], v[144:147], 0
    ds_read_b128 v[184:187], v7 offset:8192
    v_mfma_f32_16x16x32_bf16 v[88:91], v[144:147], v[144:147], 0
    ds_read_b64_tr_b16 v[200:201], v4 offset:10240
    v_mfma_f32_16x16x32_bf16 v[80:83], v[160:163], v[144:147], 0
    ds_read_b64_tr_b16 v[202:203], v5 offset:10240
    v_mfma_f32_16x16x32_bf16 v[64:67], v[152:155], v[144:147], 0
    ds_read_b128 v[188:191], v14 offset:8192
    ds_read_b64_tr_b16 v[192:193], v2 offset:10240
    v_mfma_f32_16x16x32_bf16 v[72:75], v[152:155], v[148:151], 0
    ds_read_b64_tr_b16 v[194:195], v2 offset:10752
    v_mfma_f32_16x16x32_bf16 v[68:71], v[156:159], v[144:147], 0
    s_waitcnt lgkmcnt(13)
    v_mfma_f32_16x16x32_bf16 v[76:79], v[156:159], v[148:151], 0
    ds_read_b64_tr_b16 v[196:197], v3 offset:10240
    ds_read_b64_tr_b16 v[198:199], v3 offset:10752
    s_waitcnt lgkmcnt(8)
    v_mfma_f32_16x16x32_bf16 v[84:87], v[100:103], v[164:167], v[84:87]
    ds_read_b128 v[144:147], v8 offset:8192
    v_mfma_f32_16x16x32_bf16 v[88:91], v[164:167], v[164:167], v[88:91]
    ds_read_b64_tr_b16 v[160:161], v4 offset:15360
    v_mfma_f32_16x16x32_bf16 v[80:83], v[180:183], v[164:167], v[80:83]
    ds_read_b64_tr_b16 v[162:163], v5 offset:15360
    v_mfma_f32_16x16x32_bf16 v[64:67], v[172:175], v[164:167], v[64:67]
    ds_read_b128 v[148:151], v15 offset:8192
    ds_read_b64_tr_b16 v[152:153], v2 offset:15360
    v_mfma_f32_16x16x32_bf16 v[72:75], v[172:175], v[168:171], v[72:75]
    ds_read_b64_tr_b16 v[154:155], v2 offset:15872
    v_mfma_f32_16x16x32_bf16 v[68:71], v[176:179], v[164:167], v[68:71]
    s_waitcnt lgkmcnt(13)
    v_mfma_f32_16x16x32_bf16 v[76:79], v[176:179], v[168:171], v[76:79]
    ds_read_b64_tr_b16 v[156:157], v3 offset:15360
    ds_read_b64_tr_b16 v[158:159], v3 offset:15872
    s_waitcnt lgkmcnt(8)
    s_barrier
    v_mfma_f32_16x16x32_bf16 v[84:87], v[100:103], v[184:187], v[84:87]
    ds_read_b128 v[164:167], v7 offset:16384
    v_mfma_f32_16x16x32_bf16 v[88:91], v[184:187], v[184:187], v[88:91]
    ds_read_b64_tr_b16 v[180:181], v4 offset:20480
    v_mfma_f32_16x16x32_bf16 v[80:83], v[200:203], v[184:187], v[80:83]
    ds_read_b64_tr_b16 v[182:183], v5 offset:20480
    v_mfma_f32_16x16x32_bf16 v[64:67], v[192:195], v[184:187], v[64:67]
    ds_read_b128 v[168:171], v14 offset:16384
    ds_read_b64_tr_b16 v[172:173], v2 offset:20480
    v_mfma_f32_16x16x32_bf16 v[72:75], v[192:195], v[188:191], v[72:75]
    ds_read_b64_tr_b16 v[174:175], v2 offset:20992
    v_mfma_f32_16x16x32_bf16 v[68:71], v[196:199], v[184:187], v[68:71]
    s_waitcnt lgkmcnt(13)
    v_mfma_f32_16x16x32_bf16 v[76:79], v[196:199], v[188:191], v[76:79]
    ds_read_b64_tr_b16 v[176:177], v3 offset:20480
    ds_read_b64_tr_b16 v[178:179], v3 offset:20992
    s_waitcnt lgkmcnt(8)
    v_mfma_f32_16x16x32_bf16 v[84:87], v[100:103], v[144:147], v[84:87]
    ds_read_b128 v[184:187], v8 offset:16384
    v_mfma_f32_16x16x32_bf16 v[88:91], v[144:147], v[144:147], v[88:91]
    ds_read_b64_tr_b16 v[200:201], v4 offset:25600
    v_mfma_f32_16x16x32_bf16 v[80:83], v[160:163], v[144:147], v[80:83]
    ds_read_b64_tr_b16 v[202:203], v5 offset:25600
    v_mfma_f32_16x16x32_bf16 v[64:67], v[152:155], v[144:147], v[64:67]
    ds_read_b128 v[188:191], v15 offset:16384
    ds_read_b64_tr_b16 v[192:193], v2 offset:25600
    v_mfma_f32_16x16x32_bf16 v[72:75], v[152:155], v[148:151], v[72:75]
    ds_read_b64_tr_b16 v[194:195], v2 offset:26112
    v_mfma_f32_16x16x32_bf16 v[68:71], v[156:159], v[144:147], v[68:71]
    s_waitcnt lgkmcnt(13)
    v_mfma_f32_16x16x32_bf16 v[76:79], v[156:159], v[148:151], v[76:79]
    ds_read_b64_tr_b16 v[196:197], v3 offset:25600
    ds_read_b64_tr_b16 v[198:199], v3 offset:26112
    s_waitcnt lgkmcnt(8)
    v_mfma_f32_16x16x32_bf16 v[84:87], v[100:103], v[164:167], v[84:87]
    ds_read_b128 v[144:147], v7 offset:24576
    v_mfma_f32_16x16x32_bf16 v[88:91], v[164:167], v[164:167], v[88:91]
    ds_read_b64_tr_b16 v[160:161], v4 offset:30720
    v_mfma_f32_16x16x32_bf16 v[80:83], v[180:183], v[164:167], v[80:83]
    ds_read_b64_tr_b16 v[162:163], v5 offset:30720
    v_mfma_f32_16x16x32_bf16 v[64:67], v[172:175], v[164:167], v[64:67]
    ds_read_b128 v[148:151], v14 offset:24576
    ds_read_b64_tr_b16 v[152:153], v2 offset:30720
    v_mfma_f32_16x16x32_bf16 v[72:75], v[172:175], v[168:171], v[72:75]
    ds_read_b64_tr_b16 v[154:155], v2 offset:31232
    v_mfma_f32_16x16x32_bf16 v[68:71], v[176:179], v[164:167], v[68:71]
    s_waitcnt lgkmcnt(13)
    v_mfma_f32_16x16x32_bf16 v[76:79], v[176:179], v[168:171], v[76:79]
    ds_read_b64_tr_b16 v[156:157], v3 offset:30720
    ds_read_b64_tr_b16 v[158:159], v3 offset:31232
    s_waitcnt lgkmcnt(8)
    v_mfma_f32_16x16x32_bf16 v[84:87], v[100:103], v[184:187], v[84:87]
    ds_read_b128 v[164:167], v8 offset:24576
    v_mfma_f32_16x16x32_bf16 v[88:91], v[184:187], v[184:187], v[88:91]
    ds_read_b64_tr_b16 v[180:181], v4 offset:35840
    v_mfma_f32_16x16x32_bf16 v[80:83], v[200:203], v[184:187], v[80:83]
    ds_read_b64_tr_b16 v[182:183], v5 offset:35840
    v_mfma_f32_16x16x32_bf16 v[64:67], v[192:195], v[184:187], v[64:67]
    ds_read_b128 v[168:171], v15 offset:24576
    ds_read_b64_tr_b16 v[172:173], v2 offset:35840
    v_mfma_f32_16x16x32_bf16 v[72:75], v[192:195], v[188:191], v[72:75]
    ds_read_b64_tr_b16 v[174:175], v2 offset:36352
    v_mfma_f32_16x16x32_bf16 v[68:71], v[196:199], v[184:187], v[68:71]
    s_waitcnt lgkmcnt(13)
    v_mfma_f32_16x16x32_bf16 v[76:79], v[196:199], v[188:191], v[76:79]
    ds_read_b64_tr_b16 v[176:177], v3 offset:35840
    ds_read_b64_tr_b16 v[178:179], v3 offset:36352
    s_waitcnt lgkmcnt(8)
    s_barrier
    v_add_u32 v7, 32768, v7
    v_add_u32 v8, 32768, v8
    v_add_u32 v14, 32768, v14
    v_add_u32 v15, 32768, v15
    v_add_u32 v2, 40960, v2
    v_add_u32 v3, 40960, v3
    v_add_u32 v4, 40960, v4
    v_add_u32 v5, 40960, v5
    v_mfma_f32_16x16x32_bf16 v[84:87], v[100:103], v[144:147], v[84:87]
    ds_read_b128 v[184:187], v7 offset:0
    v_mfma_f32_16x16x32_bf16 v[88:91], v[144:147], v[144:147], v[88:91]
    ds_read_b64_tr_b16 v[200:201], v4 offset:0
    v_mfma_f32_16x16x32_bf16 v[80:83], v[160:163], v[144:147], v[80:83]
    ds_read_b64_tr_b16 v[202:203], v5 offset:0
    v_mfma_f32_16x16x32_bf16 v[64:67], v[152:155], v[144:147], v[64:67]
    ds_read_b128 v[188:191], v14 offset:0
    ds_read_b64_tr_b16 v[192:193], v2 offset:0
    v_mfma_f32_16x16x32_bf16 v[72:75], v[152:155], v[148:151], v[72:75]
    ds_read_b64_tr_b16 v[194:195], v2 offset:512
    v_mfma_f32_16x16x32_bf16 v[68:71], v[156:159], v[144:147], v[68:71]
    s_waitcnt lgkmcnt(13)
    v_mfma_f32_16x16x32_bf16 v[76:79], v[156:159], v[148:151], v[76:79]
    ds_read_b64_tr_b16 v[196:197], v3 offset:0
    ds_read_b64_tr_b16 v[198:199], v3 offset:512
    s_waitcnt lgkmcnt(8)
    v_mfma_f32_16x16x32_bf16 v[84:87], v[100:103], v[164:167], v[84:87]
    ds_read_b128 v[144:147], v8 offset:0
    v_mfma_f32_16x16x32_bf16 v[88:91], v[164:167], v[164:167], v[88:91]
    ds_read_b64_tr_b16 v[160:161], v4 offset:5120
    v_mfma_f32_16x16x32_bf16 v[80:83], v[180:183], v[164:167], v[80:83]
    ds_read_b64_tr_b16 v[162:163], v5 offset:5120
    v_mfma_f32_16x16x32_bf16 v[64:67], v[172:175], v[164:167], v[64:67]
    ds_read_b128 v[148:151], v15 offset:0
    ds_read_b64_tr_b16 v[152:153], v2 offset:5120
    v_mfma_f32_16x16x32_bf16 v[72:75], v[172:175], v[168:171], v[72:75]
    ds_read_b64_tr_b16 v[154:155], v2 offset:5632
    v_mfma_f32_16x16x32_bf16 v[68:71], v[176:179], v[164:167], v[68:71]
    s_waitcnt lgkmcnt(13)
    v_mfma_f32_16x16x32_bf16 v[76:79], v[176:179], v[168:171], v[76:79]
    ds_read_b64_tr_b16 v[156:157], v3 offset:5120
    ds_read_b64_tr_b16 v[158:159], v3 offset:5632
    s_waitcnt lgkmcnt(8)
    v_mfma_f32_16x16x32_bf16 v[84:87], v[100:103], v[184:187], v[84:87]
    ds_read_b128 v[164:167], v7 offset:8192
    v_mfma_f32_16x16x32_bf16 v[88:91], v[184:187], v[184:187], v[88:91]
    ds_read_b64_tr_b16 v[180:181], v4 offset:10240
    v_mfma_f32_16x16x32_bf16 v[80:83], v[200:203], v[184:187], v[80:83]
    ds_read_b64_tr_b16 v[182:183], v5 offset:10240
    v_mfma_f32_16x16x32_bf16 v[64:67], v[192:195], v[184:187], v[64:67]
    ds_read_b128 v[168:171], v14 offset:8192
    ds_read_b64_tr_b16 v[172:173], v2 offset:10240
    v_mfma_f32_16x16x32_bf16 v[72:75], v[192:195], v[188:191], v[72:75]
    ds_read_b64_tr_b16 v[174:175], v2 offset:10752
    v_mfma_f32_16x16x32_bf16 v[68:71], v[196:199], v[184:187], v[68:71]
    s_waitcnt lgkmcnt(13)
    v_mfma_f32_16x16x32_bf16 v[76:79], v[196:199], v[188:191], v[76:79]
    ds_read_b64_tr_b16 v[176:177], v3 offset:10240
    ds_read_b64_tr_b16 v[178:179], v3 offset:10752
    s_waitcnt lgkmcnt(8)
    v_mfma_f32_16x16x32_bf16 v[84:87], v[100:103], v[144:147], v[84:87]
    ds_read_b128 v[184:187], v8 offset:8192
    v_mfma_f32_16x16x32_bf16 v[88:91], v[144:147], v[144:147], v[88:91]
    ds_read_b64_tr_b16 v[200:201], v4 offset:15360
    v_mfma_f32_16x16x32_bf16 v[80:83], v[160:163], v[144:147], v[80:83]
    ds_read_b64_tr_b16 v[202:203], v5 offset:15360
    v_mfma_f32_16x16x32_bf16 v[64:67], v[152:155], v[144:147], v[64:67]
    ds_read_b128 v[188:191], v15 offset:8192
    ds_read_b64_tr_b16 v[192:193], v2 offset:15360
    v_mfma_f32_16x16x32_bf16 v[72:75], v[152:155], v[148:151], v[72:75]
    ds_read_b64_tr_b16 v[194:195], v2 offset:15872
    v_mfma_f32_16x16x32_bf16 v[68:71], v[156:159], v[144:147], v[68:71]
    s_waitcnt lgkmcnt(13)
    v_mfma_f32_16x16x32_bf16 v[76:79], v[156:159], v[148:151], v[76:79]
    ds_read_b64_tr_b16 v[196:197], v3 offset:15360
    ds_read_b64_tr_b16 v[198:199], v3 offset:15872
    s_waitcnt lgkmcnt(8)
    s_barrier
    v_mfma_f32_16x16x32_bf16 v[84:87], v[100:103], v[164:167], v[84:87]
    ds_read_b128 v[144:147], v7 offset:16384
    v_mfma_f32_16x16x32_bf16 v[88:91], v[164:167], v[164:167], v[88:91]
    ds_read_b64_tr_b16 v[160:161], v4 offset:20480
    v_mfma_f32_16x16x32_bf16 v[80:83], v[180:183], v[164:167], v[80:83]
    ds_read_b64_tr_b16 v[162:163], v5 offset:20480
    v_mfma_f32_16x16x32_bf16 v[64:67], v[172:175], v[164:167], v[64:67]
    ds_read_b128 v[148:151], v14 offset:16384
    ds_read_b64_tr_b16 v[152:153], v2 offset:20480
    v_mfma_f32_16x16x32_bf16 v[72:75], v[172:175], v[168:171], v[72:75]
    ds_read_b64_tr_b16 v[154:155], v2 offset:20992
    v_mfma_f32_16x16x32_bf16 v[68:71], v[176:179], v[164:167], v[68:71]
    s_waitcnt lgkmcnt(13)
    v_mfma_f32_16x16x32_bf16 v[76:79], v[176:179], v[168:171], v[76:79]
    ds_read_b64_tr_b16 v[156:157], v3 offset:20480
    ds_read_b64_tr_b16 v[158:159], v3 offset:20992
    s_waitcnt lgkmcnt(8)
    v_mfma_f32_16x16x32_bf16 v[84:87], v[100:103], v[184:187], v[84:87]
    ds_read_b128 v[164:167], v8 offset:16384
    v_mfma_f32_16x16x32_bf16 v[88:91], v[184:187], v[184:187], v[88:91]
    ds_read_b64_tr_b16 v[180:181], v4 offset:25600
    v_mfma_f32_16x16x32_bf16 v[80:83], v[200:203], v[184:187], v[80:83]
    ds_read_b64_tr_b16 v[182:183], v5 offset:25600
    v_mfma_f32_16x16x32_bf16 v[64:67], v[192:195], v[184:187], v[64:67]
    ds_read_b128 v[168:171], v15 offset:16384
    ds_read_b64_tr_b16 v[172:173], v2 offset:25600
    v_mfma_f32_16x16x32_bf16 v[72:75], v[192:195], v[188:191], v[72:75]
    ds_read_b64_tr_b16 v[174:175], v2 offset:26112
    v_mfma_f32_16x16x32_bf16 v[68:71], v[196:199], v[184:187], v[68:71]
    s_waitcnt lgkmcnt(13)
    v_mfma_f32_16x16x32_bf16 v[76:79], v[196:199], v[188:191], v[76:79]
    ds_read_b64_tr_b16 v[176:177], v3 offset:25600
    ds_read_b64_tr_b16 v[178:179], v3 offset:26112
    s_waitcnt lgkmcnt(8)
    v_mfma_f32_16x16x32_bf16 v[84:87], v[100:103], v[144:147], v[84:87]
    ds_read_b128 v[184:187], v7 offset:24576
    v_mfma_f32_16x16x32_bf16 v[88:91], v[144:147], v[144:147], v[88:91]
    ds_read_b64_tr_b16 v[200:201], v4 offset:30720
    v_mfma_f32_16x16x32_bf16 v[80:83], v[160:163], v[144:147], v[80:83]
    ds_read_b64_tr_b16 v[202:203], v5 offset:30720
    v_mfma_f32_16x16x32_bf16 v[64:67], v[152:155], v[144:147], v[64:67]
    ds_read_b128 v[188:191], v14 offset:24576
    ds_read_b64_tr_b16 v[192:193], v2 offset:30720
    v_mfma_f32_16x16x32_bf16 v[72:75], v[152:155], v[148:151], v[72:75]
    ds_read_b64_tr_b16 v[194:195], v2 offset:31232
    v_mfma_f32_16x16x32_bf16 v[68:71], v[156:159], v[144:147], v[68:71]
    s_waitcnt lgkmcnt(13)
    v_mfma_f32_16x16x32_bf16 v[76:79], v[156:159], v[148:151], v[76:79]
    ds_read_b64_tr_b16 v[196:197], v3 offset:30720
    ds_read_b64_tr_b16 v[198:199], v3 offset:31232
    s_waitcnt lgkmcnt(8)
    v_mfma_f32_16x16x32_bf16 v[84:87], v[100:103], v[164:167], v[84:87]
    ds_read_b128 v[144:147], v8 offset:24576
    v_mfma_f32_16x16x32_bf16 v[88:91], v[164:167], v[164:167], v[88:91]
    ds_read_b64_tr_b16 v[160:161], v4 offset:35840
    v_mfma_f32_16x16x32_bf16 v[80:83], v[180:183], v[164:167], v[80:83]
    ds_read_b64_tr_b16 v[162:163], v5 offset:35840
    v_mfma_f32_16x16x32_bf16 v[64:67], v[172:175], v[164:167], v[64:67]
    ds_read_b128 v[148:151], v15 offset:24576
    ds_read_b64_tr_b16 v[152:153], v2 offset:35840
    v_mfma_f32_16x16x32_bf16 v[72:75], v[172:175], v[168:171], v[72:75]
    ds_read_b64_tr_b16 v[154:155], v2 offset:36352
    v_mfma_f32_16x16x32_bf16 v[68:71], v[176:179], v[164:167], v[68:71]
    s_waitcnt lgkmcnt(13)
    v_mfma_f32_16x16x32_bf16 v[76:79], v[176:179], v[168:171], v[76:79]
    ds_read_b64_tr_b16 v[156:157], v3 offset:35840
    ds_read_b64_tr_b16 v[158:159], v3 offset:36352
    s_waitcnt vmcnt(0)
    s_cmp_ge_u32 s57, 648
    s_cbranch_scc1 L_q_nowo2
    v_lshl_or_b32 v140, v129, 16, v128
    v_lshl_or_b32 v141, v131, 16, v130
    v_lshl_or_b32 v142, v133, 16, v132
    v_lshl_or_b32 v143, v135, 16, v134
    buffer_store_dwordx4 v[140:143], v6, s[32:35], s58 offen offset:0 sc1
L_q_nowo2:
    s_waitcnt lgkmcnt(8)
    s_barrier
    v_add_u32 v7, 32768, v7
    v_add_u32 v8, 32768, v8
    v_add_u32 v14, 32768, v14
    v_add_u32 v15, 32768, v15
    v_add_u32 v2, 40960, v2
    v_add_u32 v3, 40960, v3
    v_add_u32 v4, 40960, v4
    v_add_u32 v5, 40960, v5
    v_mfma_f32_16x16x32_bf16 v[84:87], v[100:103], v[184:187], v[84:87]
    ds_read_b128 v[164:167], v7 offset:0
    v_mfma_f32_16x16x32_bf16 v[88:91], v[184:187], v[184:187], v[88:91]
    ds_read_b64_tr_b16 v[180:181], v4 offset:0
    v_mfma_f32_16x16x32_bf16 v[80:83], v[200:203], v[184:187], v[80:83]
    ds_read_b64_tr_b16 v[182:183], v5 offset:0
    v_mfma_f32_16x16x32_bf16 v[64:67], v[192:195], v[184:187], v[64:67]
    ds_read_b128 v[168:171], v14 offset:0
    ds_read_b64_tr_b16 v[172:173], v2 offset:0
    v_mfma_f32_16x16x32_bf16 v[72:75], v[192:195], v[188:191], v[72:75]
    ds_read_b64_tr_b16 v[174:175], v2 offset:512
    v_mfma_f32_16x16x32_bf16 v[68:71], v[196:199], v[184:187], v[68:71]
    s_waitcnt lgkmcnt(13)
    v_mfma_f32_16x16x32_bf16 v[76:79], v[196:199], v[188:191], v[76:79]
    ds_read_b64_tr_b16 v[176:177], v3 offset:0
    ds_read_b64_tr_b16 v[178:179], v3 offset:512
    s_waitcnt lgkmcnt(8)
    v_subrev_u32 v2, 81920, v2
    v_subrev_u32 v3, 81920, v3
    v_subrev_u32 v4, 81920, v4
    v_subrev_u32 v5, 81920, v5
    v_mfma_f32_16x16x32_bf16 v[84:87], v[100:103], v[144:147], v[84:87]
    ds_read_b128 v[184:187], v8 offset:0
    v_mfma_f32_16x16x32_bf16 v[88:91], v[144:147], v[144:147], v[88:91]
    ds_read_b64_tr_b16 v[200:201], v4 offset:0
    v_mfma_f32_16x16x32_bf16 v[80:83], v[160:163], v[144:147], v[80:83]
    ds_read_b64_tr_b16 v[202:203], v5 offset:0
    v_mfma_f32_16x16x32_bf16 v[64:67], v[152:155], v[144:147], v[64:67]
    ds_read_b128 v[188:191], v15 offset:0
    ds_read_b64_tr_b16 v[192:193], v2 offset:0
    v_mfma_f32_16x16x32_bf16 v[72:75], v[152:155], v[148:151], v[72:75]
    ds_read_b64_tr_b16 v[194:195], v2 offset:512
    v_mfma_f32_16x16x32_bf16 v[68:71], v[156:159], v[144:147], v[68:71]
    s_waitcnt lgkmcnt(13)
    v_mfma_f32_16x16x32_bf16 v[76:79], v[156:159], v[148:151], v[76:79]
    ds_read_b64_tr_b16 v[196:197], v3 offset:0
    ds_read_b64_tr_b16 v[198:199], v3 offset:512
    s_waitcnt lgkmcnt(8)
    v_mfma_f32_16x16x32_bf16 v[84:87], v[100:103], v[164:167], v[84:87]
    v_mfma_f32_16x16x32_bf16 v[88:91], v[164:167], v[164:167], v[88:91]
    v_mfma_f32_16x16x32_bf16 v[80:83], v[180:183], v[164:167], v[80:83]
    v_mfma_f32_16x16x32_bf16 v[64:67], v[172:175], v[164:167], v[64:67]
    v_mfma_f32_16x16x32_bf16 v[72:75], v[172:175], v[168:171], v[72:75]
    v_mfma_f32_16x16x32_bf16 v[68:71], v[176:179], v[164:167], v[68:71]
    v_mfma_f32_16x16x32_bf16 v[76:79], v[176:179], v[168:171], v[76:79]
    s_waitcnt lgkmcnt(0)
    v_mfma_f32_16x16x32_bf16 v[84:87], v[100:103], v[184:187], v[84:87]
    v_mfma_f32_16x16x32_bf16 v[88:91], v[184:187], v[184:187], v[88:91]
    v_mfma_f32_16x16x32_bf16 v[80:83], v[200:203], v[184:187], v[80:83]
    v_mfma_f32_16x16x32_bf16 v[64:67], v[192:195], v[184:187], v[64:67]
    v_mfma_f32_16x16x32_bf16 v[72:75], v[192:195], v[188:191], v[72:75]
    v_mfma_f32_16x16x32_bf16 v[68:71], v[196:199], v[184:187], v[68:71]
    v_mfma_f32_16x16x32_bf16 v[76:79], v[196:199], v[188:191], v[76:79]
    s_nop 2
    v_cndmask_b32 v15, v88, v89, s[60:61]
    v_cndmask_b32 v15, v15, v90, s[62:63]
    v_cndmask_b32 v15, v15, v91, s[64:65]
    v_mul_f32 v14, 0x3ae38e39, v84
    v_mul_f32 v15, 0x3ae38e39, v15
    v_fma_f32 v15, -v14, v14, v15
    v_max_f32 v15, 0, v15
    v_add_f32 v15, 0x3727c5ac, v15
    v_rsq_f32 v15, v15
    s_mov_b64 exec, s[68:69]
    ds_write_b64 v13, v[14:15]
    s_mov_b64 exec, -1
    s_waitcnt lgkmcnt(0)
    s_barrier
    ds_read_b64 v[14:15], v13
    ds_read_b64 v[24:25], v123
    ds_read_b128 v[16:19], v122 offset:0
    ds_read_b128 v[20:23], v122 offset:128
    ds_read_b128 v[32:35], v12 offset:64
    ds_read_b128 v[36:39], v12 offset:192
    ds_read_b128 v[40:43], v12 offset:320
    ds_read_b128 v[44:47], v12 offset:448
    s_waitcnt lgkmcnt(4)
    v_mov_b32 v13, v15
    v_mul_f32 v15, 0x3eae1a93, v15
    v_mul_f32 v25, 0x3eae1a93, v25
    v_pk_fma_f32 v[64:65], v[14:15], v[16:17], v[64:65] op_sel_hi:[0,1,1] neg_lo:[1,0,0] neg_hi:[1,0,0]
    v_pk_fma_f32 v[66:67], v[14:15], v[18:19], v[66:67] op_sel_hi:[0,1,1] neg_lo:[1,0,0] neg_hi:[1,0,0]
    v_pk_mul_f32 v[64:65], v[64:65], v[14:15] op_sel:[0,1] op_sel_hi:[1,1]
    v_pk_mul_f32 v[66:67], v[66:67], v[14:15] op_sel:[0,1] op_sel_hi:[1,1]
    v_cvt_pk_bf16_f32 v48, v64, v65
    v_cvt_pk_bf16_f32 v49, v66, v67
    ds_write_b64 v120, v[48:49] offset:0
    v_pk_fma_f32 v[68:69], v[14:15], v[20:21], v[68:69] op_sel_hi:[0,1,1] neg_lo:[1,0,0] neg_hi:[1,0,0]
    v_pk_fma_f32 v[70:71], v[14:15], v[22:23], v[70:71] op_sel_hi:[0,1,1] neg_lo:[1,0,0] neg_hi:[1,0,0]
    v_pk_mul_f32 v[68:69], v[68:69], v[14:15] op_sel:[0,1] op_sel_hi:[1,1]
    v_pk_mul_f32 v[70:71], v[70:71], v[14:15] op_sel:[0,1] op_sel_hi:[1,1]
    v_cvt_pk_bf16_f32 v50, v68, v69
    v_cvt_pk_bf16_f32 v51, v70, v71
    ds_write_b64 v120, v[50:51] offset:32
    v_pk_fma_f32 v[72:73], v[24:25], v[16:17], v[72:73] op_sel_hi:[0,1,1] neg_lo:[1,0,0] neg_hi:[1,0,0]
    v_pk_fma_f32 v[74:75], v[24:25], v[18:19], v[74:75] op_sel_hi:[0,1,1] neg_lo:[1,0,0] neg_hi:[1,0,0]
    v_pk_mul_f32 v[72:73], v[72:73], v[24:25] op_sel:[0,1] op_sel_hi:[1,1]
    v_pk_mul_f32 v[74:75], v[74:75], v[24:25] op_sel:[0,1] op_sel_hi:[1,1]
    v_cvt_pk_bf16_f32 v52, v72, v73
    v_cvt_pk_bf16_f32 v53, v74, v75
    ds_write_b64 v121, v[52:53] offset:0
    v_pk_fma_f32 v[76:77], v[24:25], v[20:21], v[76:77] op_sel_hi:[0,1,1] neg_lo:[1,0,0] neg_hi:[1,0,0]
    v_pk_fma_f32 v[78:79], v[24:25], v[22:23], v[78:79] op_sel_hi:[0,1,1] neg_lo:[1,0,0] neg_hi:[1,0,0]
    v_pk_mul_f32 v[76:77], v[76:77], v[24:25] op_sel:[0,1] op_sel_hi:[1,1]
    v_pk_mul_f32 v[78:79], v[78:79], v[24:25] op_sel:[0,1] op_sel_hi:[1,1]
    v_cvt_pk_bf16_f32 v54, v76, v77
    v_cvt_pk_bf16_f32 v55, v78, v79
    ds_write_b64 v121, v[54:55] offset:32
    s_waitcnt lgkmcnt(0)
    s_barrier
    v_pk_add_f32 v[32:33], v[32:33], v[40:41]
    v_pk_add_f32 v[34:35], v[34:35], v[42:43]
    v_pk_add_f32 v[36:37], v[36:37], v[44:45]
    v_pk_add_f32 v[38:39], v[38:39], v[46:47]
    v_pk_add_f32 v[32:33], v[32:33], v[36:37]
    v_pk_add_f32 v[34:35], v[34:35], v[38:39]
    v_fma_f32 v80, -v14, v32, v80
    v_fma_f32 v81, -v14, v33, v81
    v_fma_f32 v82, -v14, v34, v82
    v_fma_f32 v83, -v14, v35, v83
    s_cmp_lt_u32 s41, 4
    s_cselect_b64 vcc, -1, 0
    v_cndmask_b32 v13, v13, v15, vcc
    v_mul_f32 v80, v80, v13
    v_mul_f32 v81, v81, v13
    v_mul_f32 v82, v82, v13
    v_mul_f32 v83, v83, v13
    v_cvt_pk_bf16_f32 v56, v80, v81
    v_cvt_pk_bf16_f32 v57, v82, v83
    s_cbranch_scc0 L_q_kv
    v_lshlrev_b32 v2, 3, v10
    v_mad_u32_u24 v2, v9, s44, v2
    s_lshl_b32 s46, s41, 5
    s_add_u32 s46, s46, 1049600
    buffer_store_dwordx2 v[56:57], v2, s[32:35], s46 offen sc1
    s_branch L_q_fin
L_q_kv:
    s_lshr_b32 s45, s42, 7
    s_mul_i32 s45, s45, 9216
    s_add_u32 s45, s45, 0
    s_bfe_u32 s46, s42, 0x20005
    v_and_b32 v2, 31, v9
    s_cmp_ge_u32 s41, 6
    s_cbranch_scc1 L_q_v
    v_and_b32 v4, 4, v2
    v_and_b32 v5, 8, v2
    v_and_b32 v3, 0x13, v2
    v_lshl_or_b32 v3, v4, 1, v3
    v_lshrrev_b32 v5, 1, v5
    v_or_b32 v3, v3, v5
    v_mul_f32 v14, v80, v80
    v_fmac_f32 v14, v81, v81
    s_lshr_b32 s49, s42, 2
    s_add_u32 s49, s49, 151552
    s_cmp_eq_u32 s41, 5
    s_cbranch_scc1 L_q_k1
    v_lshrrev_b32 v4, 1, v10
    v_lshl_add_u32 v4, v4, 5, v3
    v_lshlrev_b32 v4, 4, v4
    v_and_b32 v5, 1, v10
    v_lshl_add_u32 v4, v5, 3, v4
    s_lshl_b32 s47, s46, 10
    s_add_u32 s47, s47, s45
    buffer_store_dwordx2 v[56:57], v4, s[32:35], s47 offen sc1
    v_fmac_f32 v14, v82, v82
    v_fmac_f32 v14, v83, v83
    v_mov_b32 v15, v14
    s_nop 1
    v_permlane32_swap_b32 v14, v15
    v_add_f32 v14, v14, v15
    v_mov_b32 v15, v14
    s_nop 1
    v_permlane16_swap_b32 v14, v15
    v_add_f32 v14, v14, v15
    s_branch L_q_kmax
L_q_k1:
    v_lshlrev_b32 v3, 4, v3
    s_lshl_b32 s48, s46, 2
    s_add_u32 s48, s48, s45
    s_add_u32 s48, s48, 4096
    s_add_u32 s49, s49, 512
    s_mov_b64 exec, 0xffff
    buffer_store_dword v56, v3, s[32:35], s48 offen sc1
    s_mov_b64 exec, -1
L_q_kmax:
    s_nop 1
    v_max_f32_dpp v14, v14, v14 row_ror:8 row_mask:0xf bank_mask:0xf
    s_nop 1
    v_max_f32_dpp v14, v14, v14 row_ror:4 row_mask:0xf bank_mask:0xf
    s_nop 1
    v_max_f32_dpp v14, v14, v14 row_ror:2 row_mask:0xf bank_mask:0xf
    s_nop 1
    v_max_f32_dpp v14, v14, v14 row_ror:1 row_mask:0xf bank_mask:0xf
    v_mov_b32 v2, 0
    s_mov_b64 exec, 1
    buffer_store_dword v14, v2, s[32:35], s49 offen sc1
    s_branch L_q_fin
L_q_v:
    v_lshrrev_b32 v5, 3, v2
    v_mul_u32_u24 v5, 288, v5
    v_and_b32 v4, 7, v2
    v_lshl_add_u32 v5, v4, 1, v5
    s_mul_i32 s47, s46, 1152
    s_add_u32 s47, s47, s45
    s_add_u32 s47, s47, 4608
    s_cmp_eq_u32 s41, 7
    s_cbranch_scc1 L_q_v1
    v_lshl_add_u32 v4, v10, 6, v5
    buffer_store_short v56, v4, s[32:35], s47 offen sc1
    buffer_store_short_d16_hi v56, v4, s[32:35], s47 offen offset:16 sc1
    buffer_store_short v57, v4, s[32:35], s47 offen offset:32 sc1
    buffer_store_short_d16_hi v57, v4, s[32:35], s47 offen offset:48 sc1
    s_branch L_q_fin
L_q_v1:
    s_mov_b64 exec, 0xffff
    buffer_store_short v56, v5, s[32:35], s47 offen offset:256 sc1
    buffer_store_short_d16_hi v56, v5, s[32:35], s47 offen offset:272 sc1
    s_branch L_q_fin
L_q_fin:
    s_mov_b64 exec, -1
    s_load_dwordx2 s[4:5], s[0:1], 0
    s_load_dwordx8 s[16:23], s[0:1], 48
    s_load_dwordx2 s[6:7], s[0:1], 80
    s_load_dwordx2 s[12:13], s[0:1], 96
    s_and_b32 s43, s2, 3
    s_lshl_b32 s43, s43, 1
    s_bfe_u32 s45, s2, 0x10003
    s_add_u32 s43, s43, s45
    s_lshr_b32 s56, s2, 4
    s_lshl_b32 s56, s56, 1
    s_bfe_u32 s45, s2, 0x10002
    s_add_u32 s56, s56, s45
    s_lshl_b32 s57, s56, 3
    s_add_u32 s57, s57, s43
    s_lshl_b32 s42, s57, 3
    s_and_b32 s40, s3, 3
    s_lshr_b32 s41, s3, 2
    s_movk_i32 s44, 1152
    v_and_b32 v5, 15, v1
    v_mul_u32_u24 v5, 36, v5
    v_bfe_u32 v6, v1, 4, 1
    v_mad_u32_u24 v5, v6, s44, v5
    v_lshrrev_b32 v7, 5, v1
    v_lshl_add_u32 v6, v7, 4, v5
    s_and_b32 s45, s40, 2
    s_lshl_b32 s45, s45, 1
    s_add_u32 s45, s45, s42
    s_mul_i32 s45, s45, 1152
    s_mul_i32 s46, s41, 576
    s_add_u32 s45, s45, s46
    s_add_u32 s45, s45, 1048576
    v_lshlrev_b32 v8, 3, v1
    v_lshlrev_b32 v9, 4, v1
    s_lshl_b32 s47, s3, 10
    s_waitcnt lgkmcnt(0)
    v_mov_b32 v140, v5
    v_mov_b32 v141, v6
    s_mov_b32 s31, s45
    s_mov_b32 s36, s4
    s_and_b32 s37, s5, 0xffff
    s_mov_b32 s38, 2359296
    s_mov_b32 s39, 0x00020000
    s_mul_i32 s70, s3, 165888
    s_mul_i32 s47, s43, 1327104
    s_add_u32 s70, s70, s47
    s_add_u32 s70, s70, 6291456
    s_mov_b32 s64, s12
    s_and_b32 s65, s13, 0xffff
    s_add_u32 s66, s70, 165888
    s_mov_b32 s67, 0x00020000
    s_mov_b32 s54, 0x00ff00ff
    s_mov_b32 s55, 0x00ff00ff
    s_and_b32 s10, s40, 1
    s_mul_i32 s11, s10, 9216
    v_add_u32 v2, s11, v9
    s_mov_b32 s50, -1
    s_mov_b32 s51, 0
    s_mov_b32 s8, 0x3ffff
    s_mov_b32 s9, 0x3ffff
    v_and_b32 v5, 31, v1
    v_and_b32 v8, 4, v5
    v_and_b32 v3, 8, v5
    v_and_b32 v6, 0x13, v5
    v_lshl_or_b32 v6, v8, 1, v6
    v_lshrrev_b32 v3, 1, v3
    v_or_b32 v6, v6, v3
    v_lshlrev_b32 v6, 4, v6
    s_movk_i32 s46, 288
    v_mad_u32_u24 v4, v7, s46, v6
    s_add_u32 s46, s11, 4608
    v_add_u32 v4, s46, v4
    v_mov_b64 v[72:73], 0
    v_mov_b64 v[74:75], 0
    v_mov_b64 v[10:11], 0
    v_mov_b32 v13, 0
    v_mov_b32 v14, 0
    v_mov_b32 v17, 0
    v_mov_b32 v18, 0
    v_mfma_f32_32x32x16_bf16 v[76:91], v[72:75], v[72:75], 0
    v_mfma_f32_32x32x16_bf16 v[92:107], v[72:75], v[72:75], 0
    v_and_b32 v5, 27, v5
    v_cmp_eq_u32 vcc, 18, v5
    v_mov_b32 v116, 0x3f803f80
    v_mov_b32 v117, 0x3f803f80
    v_cndmask_b32 v124, 0, v116, vcc
    v_cndmask_b32 v125, 0, v116, vcc
    v_mov_b64 v[126:127], v[124:125]
    v_mov_b64 v[128:129], v[124:125]
    v_mov_b64 v[130:131], v[124:125]
    v_mov_b64 v[132:133], v[124:125]
    v_mov_b64 v[134:135], v[124:125]
    v_mov_b64 v[136:137], v[124:125]
    v_mov_b64 v[138:139], v[124:125]
    v_mov_b64 v[118:119], v[116:117]
    v_mov_b64 v[120:121], v[116:117]
    v_mov_b64 v[122:123], v[116:117]
    s_waitcnt vmcnt(0)
L_g_nowait:
    s_waitcnt lgkmcnt(0)
    s_barrier
    v_mov_b32 v8, 161792
    ds_read_b32 v3, v8
    v_lshlrev_b32 v8, 12, v1
    s_lshl_b32 s46, s2, 4
    s_add_u32 s46, s46, 851968
    s_waitcnt lgkmcnt(0)
    v_readfirstlane_b32 s30, v3
    s_cmp_lg_u32 s3, 4
    s_cbranch_scc1 L_g_noarr
    s_mov_b64 exec, 0xff
    buffer_store_dword v3, v8, s[32:35], s46 offen sc1
    s_mov_b64 exec, -1
L_g_noarr:
    s_cmp_lg_u32 s41, 0
    s_cbranch_scc1 L_g_poll_ok
    s_and_b32 s46, s2, 7
    s_lshl_b32 s46, s46, 2
    s_add_u32 s46, s46, s40
    s_lshl_b32 s46, s46, 10
    s_add_u32 s46, s46, 851968
    s_setprio 3
    s_mov_b32 s49, 16384
L_g_poll:
    buffer_load_dword v3, v9, s[32:35], s46 offen sc1
    s_waitcnt vmcnt(0)
    v_cmp_ne_u32 vcc, s30, v3
    s_sub_u32 s49, s49, 1
    s_cbranch_scc1 L_g_poll_ok
    s_nop 1
    s_cmp_eq_u64 vcc, 0
    s_cbranch_scc1 L_g_poll_ok
    s_sleep 2
    s_branch L_g_poll
L_g_poll_ok:
    s_barrier
    s_lshl_b32 s15, s40, 10
    s_cmp_lg_u32 s41, 0
    s_cbranch_scc0 L_a_nodma
    s_add_u32 m0, s15, 0
    s_add_u32 s46, s15, 0
    buffer_load_dwordx4 v9, s[32:35], s46 offen sc1 lds
    s_add_u32 m0, s15, 4096
    s_add_u32 s46, s15, 4096
    buffer_load_dwordx4 v9, s[32:35], s46 offen sc1 lds
    s_add_u32 m0, s15, 8192
    s_add_u32 s46, s15, 8192
    buffer_load_dwordx4 v9, s[32:35], s46 offen sc1 lds
    s_add_u32 m0, s15, 12288
    s_add_u32 s46, s15, 12288
    buffer_load_dwordx4 v9, s[32:35], s46 offen sc1 lds
    s_add_u32 m0, s15, 16384
    s_add_u32 s46, s15, 16384
    buffer_load_dwordx4 v9, s[32:35], s46 offen sc1 lds
    s_add_u32 m0, s15, 20480
    s_add_u32 s46, s15, 20480
    buffer_load_dwordx4 v9, s[32:35], s46 offen sc1 lds
    s_add_u32 m0, s15, 24576
    s_add_u32 s46, s15, 24576
    buffer_load_dwordx4 v9, s[32:35], s46 offen sc1 lds
    s_add_u32 m0, s15, 28672
    s_add_u32 s46, s15, 28672
    buffer_load_dwordx4 v9, s[32:35], s46 offen sc1 lds
    s_add_u32 m0, s15, 32768
    s_add_u32 s46, s15, 32768
    buffer_load_dwordx4 v9, s[32:35], s46 offen sc1 lds
    s_add_u32 m0, s15, 36864
    s_add_u32 s46, s15, 36864
    buffer_load_dwordx4 v9, s[32:35], s46 offen sc1 lds
    s_add_u32 m0, s15, 40960
    s_add_u32 s46, s15, 40960
    buffer_load_dwordx4 v9, s[32:35], s46 offen sc1 lds
    s_add_u32 m0, s15, 45056
    s_add_u32 s46, s15, 45056
    buffer_load_dwordx4 v9, s[32:35], s46 offen sc1 lds
    s_add_u32 m0, s15, 49152
    s_add_u32 s46, s15, 49152
    buffer_load_dwordx4 v9, s[32:35], s46 offen sc1 lds
L_a_nodma:
    buffer_load_dwordx4 v[28:31], v141, s[32:35], s31 offen offset:0 sc1
    buffer_load_dword v12, v140, s[32:35], s31 offen offset:32 sc1
    buffer_load_dwordx4 v[32:35], v141, s[32:35], s31 offen offset:2304 sc1
    buffer_load_dword v16, v140, s[32:35], s31 offen offset:2336 sc1
    s_mov_b32 s46, 151552
    buffer_load_dwordx4 v[36:39], v9, s[32:35], s46 offen sc1
    s_cmp_lg_u32 s41, 0
    s_cbranch_scc0 L_a_oldq
    s_setprio 3
    s_waitcnt vmcnt(13)
    s_barrier
    s_add_u32 m0, s15, 53248
    s_add_u32 s46, s15, 53248
    buffer_load_dwordx4 v9, s[32:35], s46 offen sc1 lds
    s_add_u32 m0, s15, 57344
    s_add_u32 s46, s15, 57344
    buffer_load_dwordx4 v9, s[32:35], s46 offen sc1 lds
    s_add_u32 m0, s15, 61440
    s_add_u32 s46, s15, 61440
    buffer_load_dwordx4 v9, s[32:35], s46 offen sc1 lds
    s_add_u32 m0, s15, 65536
    s_add_u32 s46, s15, 65536
    buffer_load_dwordx4 v9, s[32:35], s46 offen sc1 lds
    s_add_u32 m0, s15, 69632
    s_add_u32 s46, s15, 69632
    buffer_load_dwordx4 v9, s[32:35], s46 offen sc1 lds
    s_add_u32 m0, s15, 73728
    s_add_u32 s46, s15, 73728
    buffer_load_dwordx4 v9, s[32:35], s46 offen sc1 lds
    s_waitcnt vmcnt(11)
    v_mov_b32 v20, 163412
    v_mov_b32 v21, 1
    s_mov_b64 exec, 1
    ds_add_u32 v20, v21
    s_mov_b64 exec, -1
    s_add_u32 m0, s15, 77824
    s_add_u32 s46, s15, 77824
    buffer_load_dwordx4 v9, s[32:35], s46 offen sc1 lds
    s_add_u32 m0, s15, 81920
    s_add_u32 s46, s15, 81920
    buffer_load_dwordx4 v9, s[32:35], s46 offen sc1 lds
    s_add_u32 m0, s15, 86016
    s_add_u32 s46, s15, 86016
    buffer_load_dwordx4 v9, s[32:35], s46 offen sc1 lds
    s_add_u32 m0, s15, 90112
    s_add_u32 s46, s15, 90112
    buffer_load_dwordx4 v9, s[32:35], s46 offen sc1 lds
    s_add_u32 m0, s15, 94208
    s_add_u32 s46, s15, 94208
    buffer_load_dwordx4 v9, s[32:35], s46 offen sc1 lds
    s_add_u32 m0, s15, 98304
    s_add_u32 s46, s15, 98304
    buffer_load_dwordx4 v9, s[32:35], s46 offen sc1 lds
    s_add_u32 m0, s15, 102400
    s_add_u32 s46, s15, 102400
    buffer_load_dwordx4 v9, s[32:35], s46 offen sc1 lds
    s_add_u32 m0, s15, 106496
    s_add_u32 s46, s15, 106496
    buffer_load_dwordx4 v9, s[32:35], s46 offen sc1 lds
    s_add_u32 m0, s15, 110592
    s_add_u32 s46, s15, 110592
    buffer_load_dwordx4 v9, s[32:35], s46 offen sc1 lds
    s_add_u32 m0, s15, 114688
    s_add_u32 s46, s15, 114688
    buffer_load_dwordx4 v9, s[32:35], s46 offen sc1 lds
    s_add_u32 m0, s15, 118784
    s_add_u32 s46, s15, 118784
    buffer_load_dwordx4 v9, s[32:35], s46 offen sc1 lds
    s_add_u32 m0, s15, 122880
    s_add_u32 s46, s15, 122880
    buffer_load_dwordx4 v9, s[32:35], s46 offen sc1 lds
    s_add_u32 m0, s15, 126976
    s_add_u32 s46, s15, 126976
    buffer_load_dwordx4 v9, s[32:35], s46 offen sc1 lds
    s_add_u32 m0, s15, 131072
    s_add_u32 s46, s15, 131072
    buffer_load_dwordx4 v9, s[32:35], s46 offen sc1 lds
    s_add_u32 m0, s15, 135168
    s_add_u32 s46, s15, 135168
    buffer_load_dwordx4 v9, s[32:35], s46 offen sc1 lds
    s_add_u32 m0, s15, 139264
    s_add_u32 s46, s15, 139264
    buffer_load_dwordx4 v9, s[32:35], s46 offen sc1 lds
    s_add_u32 m0, s15, 143360
    s_add_u32 s46, s15, 143360
    buffer_load_dwordx4 v9, s[32:35], s46 offen sc1 lds
    s_waitcnt vmcnt(23)
    s_branch L_a_qready
L_a_oldq:
    v_lshlrev_b32 v8, 2, v1
    v_add_u32 v8, 163328, v8
    ds_write_b32 v8, v10
    s_or_b32 s46, s2, s3
    s_cbranch_scc1 L_a_noep2
    v_mov_b32 v8, s30
    s_mov_b32 s46, 153600
    s_mov_b64 exec, 1
    buffer_store_dword v8, v10, s[32:35], s46 offen sc1
    s_mov_b64 exec, -1
L_a_noep2:
    s_waitcnt vmcnt(0)
L_a_qready:
    v_dot2_f32_bf16 v5, v28, v28, 0
    v_dot2_f32_bf16 v6, v32, v32, 0
    v_dot2_f32_bf16 v5, v29, v29, v5
    v_dot2_f32_bf16 v6, v33, v33, v6
    v_dot2_f32_bf16 v5, v30, v30, v5
    v_dot2_f32_bf16 v6, v34, v34, v6
    v_dot2_f32_bf16 v5, v31, v31, v5
    v_dot2_f32_bf16 v6, v35, v35, v6
    v_max_f32 v36, v36, v37
    v_max3_f32 v36, v36, v38, v39
    s_nop 1
    v_max_f32_dpp v36, v36, v36 row_ror:8 row_mask:0xf bank_mask:0xf
    s_nop 1
    v_max_f32_dpp v36, v36, v36 row_ror:4 row_mask:0xf bank_mask:0xf
    s_nop 1
    v_max_f32_dpp v36, v36, v36 row_ror:2 row_mask:0xf bank_mask:0xf
    s_nop 1
    v_max_f32_dpp v36, v36, v36 row_ror:1 row_mask:0xf bank_mask:0xf
    v_mov_b32 v37, v36
    v_mov_b32 v7, v5
    v_mov_b32 v8, v6
    v_permlane16_swap_b32 v36, v37
    v_permlane32_swap_b32 v5, v7
    v_permlane32_swap_b32 v6, v8
    v_max_f32 v36, v36, v37
    v_add_f32 v5, v5, v7
    v_add_f32 v6, v6, v8
    v_mov_b32 v37, v36
    v_dot2_f32_bf16 v5, v12, v12, v5
    v_dot2_f32_bf16 v6, v16, v16, v6
    v_permlane32_swap_b32 v36, v37
    v_add_f32 v36, v36, v37
    v_mul_f32 v5, v5, v36
    v_mul_f32 v6, v6, v36
    v_sqrt_f32 v5, v5
    v_sqrt_f32 v6, v6
    v_mul_f32 v5, 0xbf828f5c, v5
    v_mul_f32 v6, 0xbf828f5c, v6
    v_cvt_pk_bf16_f32 v5, v5, 0
    v_cvt_pk_bf16_f32 v6, v6, 0
    v_cndmask_b32 v12, v5, v12, s[50:51]
    v_mov_b32 v15, v12
    v_cndmask_b32 v16, v6, v16, s[50:51]
    v_mov_b32 v19, v16
    s_mov_b32 s48, 0
    v_lshlrev_b32 v9, 4, v1
    s_lshl_b32 s46, s10, 3
    s_and_b32 s47, s40, 2
    s_lshl_b32 s47, s47, 1
    s_add_u32 s46, s46, s47
    s_mul_i32 s14, s46, 576
    s_add_u32 s14, s14, 147456
    s_xor_b32 s46, s46, 8
    s_mul_i32 s46, s46, 576
    s_add_u32 s46, s46, 147456
    v_lshl_add_u32 v3, v1, 2, s46
    s_cmp_lg_u32 s41, 0
    s_cbranch_scc1 L_a_young_pre
    s_mov_b32 s59, 1
    s_mov_b64 vcc, -1
    s_setprio 2
    s_waitcnt vmcnt(0) lgkmcnt(0)
    s_barrier
    ds_read_b128 v[108:111], v2 offset:0
    s_mov_b64 exec, s[50:51]
    ds_read_b128 v[116:119], v2 offset:4096
    s_mov_b64 exec, -1
    ds_read_b128 v[112:115], v2 offset:1024
    s_mov_b64 exec, s[8:9]
    ds_read_b128 v[124:127], v4 offset:0
    ds_read_b128 v[128:131], v4 offset:576
    s_mov_b64 exec, -1
    s_waitcnt lgkmcnt(3)
    v_mfma_f32_32x32x8_bf16 v[36:51], v[116:117], v[12:13], 0
    s_nop 9
    v_mfma_f32_32x32x16_bf16 v[36:51], v[108:111], v[28:31], v[36:51]
    s_nop 10
.p2align 6
L_a_loop:
    s_waitcnt lgkmcnt(0)
    v_mfma_f32_32x32x8_bf16 v[52:67], v[116:117], v[16:17], 0
    v_exp_f32 v36, v36
    v_exp_f32 v37, v37
    v_exp_f32 v38, v38
    v_exp_f32 v39, v39
    v_mfma_f32_32x32x16_bf16 v[92:107], v[136:139], v[72:75], v[92:107]
    s_mov_b64 exec, s[8:9]
    ds_read_b128 v[132:135], v4 offset:1152
    ds_read_b128 v[136:139], v4 offset:1728
    s_mov_b64 exec, -1
    v_cvt_pk_bf16_f32 v68, v36, v37
    v_cvt_pk_bf16_f32 v69, v38, v39
    v_exp_f32 v40, v40
    v_exp_f32 v41, v41
    v_exp_f32 v42, v42
    v_exp_f32 v43, v43
    v_mfma_f32_32x32x16_bf16 v[52:67], v[108:111], v[32:35], v[52:67]
    ds_read_b128 v[108:111], v2 offset:2048
    v_cvt_pk_bf16_f32 v70, v40, v41
    v_cvt_pk_bf16_f32 v71, v42, v43
    v_exp_f32 v44, v44
    v_exp_f32 v45, v45
    v_exp_f32 v46, v46
    v_exp_f32 v47, v47
    v_mfma_f32_32x32x16_bf16 v[76:91], v[124:127], v[68:71], v[76:91]
    v_cvt_pk_bf16_f32 v72, v44, v45
    v_cvt_pk_bf16_f32 v73, v46, v47
    v_exp_f32 v48, v48
    v_exp_f32 v49, v49
    v_exp_f32 v50, v50
    v_exp_f32 v51, v51
    v_cvt_pk_bf16_f32 v74, v48, v49
    v_cvt_pk_bf16_f32 v75, v50, v51
    v_mfma_f32_32x32x8_bf16 v[36:51], v[116:117], v[14:15], 0
    v_exp_f32 v52, v52
    v_exp_f32 v53, v53
    v_exp_f32 v54, v54
    v_exp_f32 v55, v55
    v_mfma_f32_32x32x16_bf16 v[76:91], v[128:131], v[72:75], v[76:91]
    v_cvt_pk_bf16_f32 v68, v52, v53
    v_cvt_pk_bf16_f32 v69, v54, v55
    v_exp_f32 v56, v56
    v_exp_f32 v57, v57
    v_exp_f32 v58, v58
    v_exp_f32 v59, v59
    v_mfma_f32_32x32x16_bf16 v[36:51], v[112:115], v[28:31], v[36:51]
    v_cvt_pk_bf16_f32 v70, v56, v57
    v_cvt_pk_bf16_f32 v71, v58, v59
    v_exp_f32 v60, v60
    v_exp_f32 v61, v61
    v_exp_f32 v62, v62
    v_exp_f32 v63, v63
    v_mfma_f32_32x32x16_bf16 v[92:107], v[124:127], v[68:71], v[92:107]
    v_cvt_pk_bf16_f32 v72, v60, v61
    v_cvt_pk_bf16_f32 v73, v62, v63
    v_exp_f32 v64, v64
    v_exp_f32 v65, v65
    v_exp_f32 v66, v66
    v_exp_f32 v67, v67
    v_cvt_pk_bf16_f32 v74, v64, v65
    v_cvt_pk_bf16_f32 v75, v66, v67
    s_cbranch_vccnz L_a_mid
L_a_mid_back:
    s_waitcnt lgkmcnt(0)
    v_mfma_f32_32x32x8_bf16 v[52:67], v[116:117], v[18:19], 0
    s_mov_b64 exec, s[50:51]
    ds_read_b128 v[120:123], v2 offset:22528
    s_mov_b64 exec, -1
    v_exp_f32 v36, v36
    v_exp_f32 v37, v37
    v_exp_f32 v38, v38
    v_exp_f32 v39, v39
    v_mfma_f32_32x32x16_bf16 v[92:107], v[128:131], v[72:75], v[92:107]
    s_mov_b64 exec, s[8:9]
    ds_read_b128 v[124:127], v4 offset:2304
    ds_read_b128 v[128:131], v4 offset:2880
    s_mov_b64 exec, -1
    v_cvt_pk_bf16_f32 v68, v36, v37
    v_cvt_pk_bf16_f32 v69, v38, v39
    v_exp_f32 v40, v40
    v_exp_f32 v41, v41
    v_exp_f32 v42, v42
    v_exp_f32 v43, v43
    v_mfma_f32_32x32x16_bf16 v[52:67], v[112:115], v[32:35], v[52:67]
    ds_read_b128 v[112:115], v2 offset:3072
    v_cvt_pk_bf16_f32 v70, v40, v41
    v_cvt_pk_bf16_f32 v71, v42, v43
    v_exp_f32 v44, v44
    v_exp_f32 v45, v45
    v_exp_f32 v46, v46
    v_exp_f32 v47, v47
    v_mfma_f32_32x32x16_bf16 v[76:91], v[132:135], v[68:71], v[76:91]
    v_cvt_pk_bf16_f32 v72, v44, v45
    v_cvt_pk_bf16_f32 v73, v46, v47
    v_exp_f32 v48, v48
    v_exp_f32 v49, v49
    v_exp_f32 v50, v50
    v_exp_f32 v51, v51
    v_cvt_pk_bf16_f32 v74, v48, v49
    v_cvt_pk_bf16_f32 v75, v50, v51
    v_mfma_f32_32x32x8_bf16 v[36:51], v[118:119], v[12:13], 0
    v_exp_f32 v52, v52
    v_exp_f32 v53, v53
    v_exp_f32 v54, v54
    v_exp_f32 v55, v55
    v_mfma_f32_32x32x16_bf16 v[76:91], v[136:139], v[72:75], v[76:91]
    v_cvt_pk_bf16_f32 v68, v52, v53
    v_cvt_pk_bf16_f32 v69, v54, v55
    v_exp_f32 v56, v56
    v_exp_f32 v57, v57
    v_exp_f32 v58, v58
    v_exp_f32 v59, v59
    v_mfma_f32_32x32x16_bf16 v[36:51], v[108:111], v[28:31], v[36:51]
    v_cvt_pk_bf16_f32 v70, v56, v57
    v_cvt_pk_bf16_f32 v71, v58, v59
    v_exp_f32 v60, v60
    v_exp_f32 v61, v61
    v_exp_f32 v62, v62
    v_exp_f32 v63, v63
    v_mfma_f32_32x32x16_bf16 v[92:107], v[132:135], v[68:71], v[92:107]
    v_cvt_pk_bf16_f32 v72, v60, v61
    v_cvt_pk_bf16_f32 v73, v62, v63
    v_exp_f32 v64, v64
    v_exp_f32 v65, v65
    v_exp_f32 v66, v66
    v_exp_f32 v67, v67
    v_cvt_pk_bf16_f32 v74, v64, v65
    v_cvt_pk_bf16_f32 v75, v66, v67
    s_waitcnt lgkmcnt(0)
    v_mfma_f32_32x32x8_bf16 v[52:67], v[118:119], v[16:17], 0
    v_exp_f32 v36, v36
    v_exp_f32 v37, v37
    v_exp_f32 v38, v38
    v_exp_f32 v39, v39
    v_mfma_f32_32x32x16_bf16 v[92:107], v[136:139], v[72:75], v[92:107]
    s_mov_b64 exec, s[8:9]
    ds_read_b128 v[132:135], v4 offset:3456
    ds_read_b128 v[136:139], v4 offset:4032
    s_mov_b64 exec, -1
    v_cvt_pk_bf16_f32 v68, v36, v37
    v_cvt_pk_bf16_f32 v69, v38, v39
    v_exp_f32 v40, v40
    v_exp_f32 v41, v41
    v_exp_f32 v42, v42
    v_exp_f32 v43, v43
    v_mfma_f32_32x32x16_bf16 v[52:67], v[108:111], v[32:35], v[52:67]
    ds_read_b128 v[108:111], v2 offset:18432
    v_cvt_pk_bf16_f32 v70, v40, v41
    v_cvt_pk_bf16_f32 v71, v42, v43
    v_exp_f32 v44, v44
    v_exp_f32 v45, v45
    v_exp_f32 v46, v46
    v_exp_f32 v47, v47
    v_mfma_f32_32x32x16_bf16 v[76:91], v[124:127], v[68:71], v[76:91]
    v_cvt_pk_bf16_f32 v72, v44, v45
    v_cvt_pk_bf16_f32 v73, v46, v47
    v_exp_f32 v48, v48
    v_exp_f32 v49, v49
    v_exp_f32 v50, v50
    v_exp_f32 v51, v51
    v_cvt_pk_bf16_f32 v74, v48, v49
    v_cvt_pk_bf16_f32 v75, v50, v51
    v_mfma_f32_32x32x8_bf16 v[36:51], v[118:119], v[14:15], 0
    v_exp_f32 v52, v52
    v_exp_f32 v53, v53
    v_exp_f32 v54, v54
    v_exp_f32 v55, v55
    v_mfma_f32_32x32x16_bf16 v[76:91], v[128:131], v[72:75], v[76:91]
    v_cvt_pk_bf16_f32 v68, v52, v53
    v_cvt_pk_bf16_f32 v69, v54, v55
    v_exp_f32 v56, v56
    v_exp_f32 v57, v57
    v_exp_f32 v58, v58
    v_exp_f32 v59, v59
    v_mfma_f32_32x32x16_bf16 v[36:51], v[112:115], v[28:31], v[36:51]
    v_cvt_pk_bf16_f32 v70, v56, v57
    v_cvt_pk_bf16_f32 v71, v58, v59
    v_exp_f32 v60, v60
    v_exp_f32 v61, v61
    v_exp_f32 v62, v62
    v_exp_f32 v63, v63
    v_mfma_f32_32x32x16_bf16 v[92:107], v[124:127], v[68:71], v[92:107]
    v_cvt_pk_bf16_f32 v72, v60, v61
    v_cvt_pk_bf16_f32 v73, v62, v63
    v_exp_f32 v64, v64
    v_exp_f32 v65, v65
    v_exp_f32 v66, v66
    v_exp_f32 v67, v67
    v_cvt_pk_bf16_f32 v74, v64, v65
    v_cvt_pk_bf16_f32 v75, v66, v67
    s_waitcnt lgkmcnt(0)
    v_mfma_f32_32x32x8_bf16 v[52:67], v[118:119], v[18:19], 0
    v_exp_f32 v36, v36
    v_exp_f32 v37, v37
    v_exp_f32 v38, v38
    v_exp_f32 v39, v39
    v_mfma_f32_32x32x16_bf16 v[92:107], v[128:131], v[72:75], v[92:107]
    s_mov_b64 exec, s[8:9]
    ds_read_b128 v[124:127], v4 offset:18432
    ds_read_b128 v[128:131], v4 offset:19008
    s_mov_b64 exec, -1
    v_cvt_pk_bf16_f32 v68, v36, v37
    v_cvt_pk_bf16_f32 v69, v38, v39
    v_exp_f32 v40, v40
    v_exp_f32 v41, v41
    v_exp_f32 v42, v42
    v_exp_f32 v43, v43
    v_mfma_f32_32x32x16_bf16 v[52:67], v[112:115], v[32:35], v[52:67]
    ds_read_b128 v[112:115], v2 offset:19456
    v_cvt_pk_bf16_f32 v70, v40, v41
    v_cvt_pk_bf16_f32 v71, v42, v43
    v_exp_f32 v44, v44
    v_exp_f32 v45, v45
    v_exp_f32 v46, v46
    v_exp_f32 v47, v47
    v_mfma_f32_32x32x16_bf16 v[76:91], v[132:135], v[68:71], v[76:91]
    v_cvt_pk_bf16_f32 v72, v44, v45
    v_cvt_pk_bf16_f32 v73, v46, v47
    v_exp_f32 v48, v48
    v_exp_f32 v49, v49
    v_exp_f32 v50, v50
    v_exp_f32 v51, v51
    v_cvt_pk_bf16_f32 v74, v48, v49
    v_cvt_pk_bf16_f32 v75, v50, v51
    v_mfma_f32_32x32x8_bf16 v[36:51], v[120:121], v[12:13], 0
    v_exp_f32 v52, v52
    v_exp_f32 v53, v53
    v_exp_f32 v54, v54
    v_exp_f32 v55, v55
    v_mfma_f32_32x32x16_bf16 v[76:91], v[136:139], v[72:75], v[76:91]
    v_cvt_pk_bf16_f32 v68, v52, v53
    v_cvt_pk_bf16_f32 v69, v54, v55
    v_exp_f32 v56, v56
    v_exp_f32 v57, v57
    v_exp_f32 v58, v58
    v_exp_f32 v59, v59
    v_mfma_f32_32x32x16_bf16 v[36:51], v[108:111], v[28:31], v[36:51]
    v_cvt_pk_bf16_f32 v70, v56, v57
    v_cvt_pk_bf16_f32 v71, v58, v59
    v_exp_f32 v60, v60
    v_exp_f32 v61, v61
    v_exp_f32 v62, v62
    v_exp_f32 v63, v63
    v_mfma_f32_32x32x16_bf16 v[92:107], v[132:135], v[68:71], v[92:107]
    v_cvt_pk_bf16_f32 v72, v60, v61
    v_cvt_pk_bf16_f32 v73, v62, v63
    v_exp_f32 v64, v64
    v_exp_f32 v65, v65
    v_exp_f32 v66, v66
    v_exp_f32 v67, v67
    v_cvt_pk_bf16_f32 v74, v64, v65
    v_cvt_pk_bf16_f32 v75, v66, v67
    s_waitcnt lgkmcnt(0)
    v_mfma_f32_32x32x8_bf16 v[52:67], v[120:121], v[16:17], 0
    v_exp_f32 v36, v36
    v_exp_f32 v37, v37
    v_exp_f32 v38, v38
    v_exp_f32 v39, v39
    v_mfma_f32_32x32x16_bf16 v[92:107], v[136:139], v[72:75], v[92:107]
    s_mov_b64 exec, s[8:9]
    ds_read_b128 v[132:135], v4 offset:19584
    ds_read_b128 v[136:139], v4 offset:20160
    s_mov_b64 exec, -1
    v_cvt_pk_bf16_f32 v68, v36, v37
    v_cvt_pk_bf16_f32 v69, v38, v39
    v_exp_f32 v40, v40
    v_exp_f32 v41, v41
    v_exp_f32 v42, v42
    v_exp_f32 v43, v43
    v_mfma_f32_32x32x16_bf16 v[52:67], v[108:111], v[32:35], v[52:67]
    ds_read_b128 v[108:111], v2 offset:20480
    v_cvt_pk_bf16_f32 v70, v40, v41
    v_cvt_pk_bf16_f32 v71, v42, v43
    v_exp_f32 v44, v44
    v_exp_f32 v45, v45
    v_exp_f32 v46, v46
    v_exp_f32 v47, v47
    v_mfma_f32_32x32x16_bf16 v[76:91], v[124:127], v[68:71], v[76:91]
    v_cvt_pk_bf16_f32 v72, v44, v45
    v_cvt_pk_bf16_f32 v73, v46, v47
    v_exp_f32 v48, v48
    v_exp_f32 v49, v49
    v_exp_f32 v50, v50
    v_exp_f32 v51, v51
    v_cvt_pk_bf16_f32 v74, v48, v49
    v_cvt_pk_bf16_f32 v75, v50, v51
    v_mfma_f32_32x32x8_bf16 v[36:51], v[120:121], v[14:15], 0
    v_exp_f32 v52, v52
    v_exp_f32 v53, v53
    v_exp_f32 v54, v54
    v_exp_f32 v55, v55
    v_mfma_f32_32x32x16_bf16 v[76:91], v[128:131], v[72:75], v[76:91]
    v_cvt_pk_bf16_f32 v68, v52, v53
    v_cvt_pk_bf16_f32 v69, v54, v55
    v_exp_f32 v56, v56
    v_exp_f32 v57, v57
    v_exp_f32 v58, v58
    v_exp_f32 v59, v59
    v_mfma_f32_32x32x16_bf16 v[36:51], v[112:115], v[28:31], v[36:51]
    v_cvt_pk_bf16_f32 v70, v56, v57
    v_cvt_pk_bf16_f32 v71, v58, v59
    v_exp_f32 v60, v60
    v_exp_f32 v61, v61
    v_exp_f32 v62, v62
    v_exp_f32 v63, v63
    v_mfma_f32_32x32x16_bf16 v[92:107], v[124:127], v[68:71], v[92:107]
    v_cvt_pk_bf16_f32 v72, v60, v61
    v_cvt_pk_bf16_f32 v73, v62, v63
    v_exp_f32 v64, v64
    v_exp_f32 v65, v65
    v_exp_f32 v66, v66
    v_exp_f32 v67, v67
    v_cvt_pk_bf16_f32 v74, v64, v65
    v_cvt_pk_bf16_f32 v75, v66, v67
    s_waitcnt lgkmcnt(0)
    v_mfma_f32_32x32x8_bf16 v[52:67], v[120:121], v[18:19], 0
    s_mov_b64 exec, s[50:51]
    ds_read_b128 v[116:119], v2 offset:40960
    s_mov_b64 exec, -1
    v_exp_f32 v36, v36
    v_exp_f32 v37, v37
    v_exp_f32 v38, v38
    v_exp_f32 v39, v39
    v_mfma_f32_32x32x16_bf16 v[92:107], v[128:131], v[72:75], v[92:107]
    s_mov_b64 exec, s[8:9]
    ds_read_b128 v[124:127], v4 offset:20736
    ds_read_b128 v[128:131], v4 offset:21312
    s_mov_b64 exec, -1
    v_cvt_pk_bf16_f32 v68, v36, v37
    v_cvt_pk_bf16_f32 v69, v38, v39
    v_exp_f32 v40, v40
    v_exp_f32 v41, v41
    v_exp_f32 v42, v42
    v_exp_f32 v43, v43
    v_mfma_f32_32x32x16_bf16 v[52:67], v[112:115], v[32:35], v[52:67]
    ds_read_b128 v[112:115], v2 offset:21504
    v_cvt_pk_bf16_f32 v70, v40, v41
    v_cvt_pk_bf16_f32 v71, v42, v43
    v_exp_f32 v44, v44
    v_exp_f32 v45, v45
    v_exp_f32 v46, v46
    v_exp_f32 v47, v47
    v_mfma_f32_32x32x16_bf16 v[76:91], v[132:135], v[68:71], v[76:91]
    v_cvt_pk_bf16_f32 v72, v44, v45
    v_cvt_pk_bf16_f32 v73, v46, v47
    v_exp_f32 v48, v48
    v_exp_f32 v49, v49
    v_exp_f32 v50, v50
    v_exp_f32 v51, v51
    v_cvt_pk_bf16_f32 v74, v48, v49
    v_cvt_pk_bf16_f32 v75, v50, v51
    v_mfma_f32_32x32x8_bf16 v[36:51], v[122:123], v[12:13], 0
    v_exp_f32 v52, v52
    v_exp_f32 v53, v53
    v_exp_f32 v54, v54
    v_exp_f32 v55, v55
    v_mfma_f32_32x32x16_bf16 v[76:91], v[136:139], v[72:75], v[76:91]
    v_cvt_pk_bf16_f32 v68, v52, v53
    v_cvt_pk_bf16_f32 v69, v54, v55
    v_exp_f32 v56, v56
    v_exp_f32 v57, v57
    v_exp_f32 v58, v58
    v_exp_f32 v59, v59
    v_mfma_f32_32x32x16_bf16 v[36:51], v[108:111], v[28:31], v[36:51]
    v_cvt_pk_bf16_f32 v70, v56, v57
    v_cvt_pk_bf16_f32 v71, v58, v59
    v_exp_f32 v60, v60
    v_exp_f32 v61, v61
    v_exp_f32 v62, v62
    v_exp_f32 v63, v63
    v_mfma_f32_32x32x16_bf16 v[92:107], v[132:135], v[68:71], v[92:107]
    v_cvt_pk_bf16_f32 v72, v60, v61
    v_cvt_pk_bf16_f32 v73, v62, v63
    v_exp_f32 v64, v64
    v_exp_f32 v65, v65
    v_exp_f32 v66, v66
    v_exp_f32 v67, v67
    v_cvt_pk_bf16_f32 v74, v64, v65
    v_cvt_pk_bf16_f32 v75, v66, v67
    s_waitcnt lgkmcnt(0)
    v_mfma_f32_32x32x8_bf16 v[52:67], v[122:123], v[16:17], 0
    v_exp_f32 v36, v36
    v_exp_f32 v37, v37
    v_exp_f32 v38, v38
    v_exp_f32 v39, v39
    v_mfma_f32_32x32x16_bf16 v[92:107], v[136:139], v[72:75], v[92:107]
    s_mov_b64 exec, s[8:9]
    ds_read_b128 v[132:135], v4 offset:21888
    ds_read_b128 v[136:139], v4 offset:22464
    s_mov_b64 exec, -1
    v_cvt_pk_bf16_f32 v68, v36, v37
    v_cvt_pk_bf16_f32 v69, v38, v39
    v_exp_f32 v40, v40
    v_exp_f32 v41, v41
    v_exp_f32 v42, v42
    v_exp_f32 v43, v43
    v_mfma_f32_32x32x16_bf16 v[52:67], v[108:111], v[32:35], v[52:67]
    ds_read_b128 v[108:111], v2 offset:36864
    v_cvt_pk_bf16_f32 v70, v40, v41
    v_cvt_pk_bf16_f32 v71, v42, v43
    v_exp_f32 v44, v44
    v_exp_f32 v45, v45
    v_exp_f32 v46, v46
    v_exp_f32 v47, v47
    v_mfma_f32_32x32x16_bf16 v[76:91], v[124:127], v[68:71], v[76:91]
    v_cvt_pk_bf16_f32 v72, v44, v45
    v_cvt_pk_bf16_f32 v73, v46, v47
    v_exp_f32 v48, v48
    v_exp_f32 v49, v49
    v_exp_f32 v50, v50
    v_exp_f32 v51, v51
    v_cvt_pk_bf16_f32 v74, v48, v49
    v_cvt_pk_bf16_f32 v75, v50, v51
    v_mfma_f32_32x32x8_bf16 v[36:51], v[122:123], v[14:15], 0
    v_exp_f32 v52, v52
    v_exp_f32 v53, v53
    v_exp_f32 v54, v54
    v_exp_f32 v55, v55
    v_mfma_f32_32x32x16_bf16 v[76:91], v[128:131], v[72:75], v[76:91]
    v_cvt_pk_bf16_f32 v68, v52, v53
    v_cvt_pk_bf16_f32 v69, v54, v55
    v_exp_f32 v56, v56
    v_exp_f32 v57, v57
    v_exp_f32 v58, v58
    v_exp_f32 v59, v59
    v_mfma_f32_32x32x16_bf16 v[36:51], v[112:115], v[28:31], v[36:51]
    v_cvt_pk_bf16_f32 v70, v56, v57
    v_cvt_pk_bf16_f32 v71, v58, v59
    v_exp_f32 v60, v60
    v_exp_f32 v61, v61
    v_exp_f32 v62, v62
    v_exp_f32 v63, v63
    v_mfma_f32_32x32x16_bf16 v[92:107], v[124:127], v[68:71], v[92:107]
    v_cvt_pk_bf16_f32 v72, v60, v61
    v_cvt_pk_bf16_f32 v73, v62, v63
    v_exp_f32 v64, v64
    v_exp_f32 v65, v65
    v_exp_f32 v66, v66
    v_exp_f32 v67, v67
    v_cvt_pk_bf16_f32 v74, v64, v65
    v_cvt_pk_bf16_f32 v75, v66, v67
    s_waitcnt lgkmcnt(0)
    v_mfma_f32_32x32x8_bf16 v[52:67], v[122:123], v[18:19], 0
    v_exp_f32 v36, v36
    v_exp_f32 v37, v37
    v_exp_f32 v38, v38
    v_exp_f32 v39, v39
    v_mfma_f32_32x32x16_bf16 v[92:107], v[128:131], v[72:75], v[92:107]
    s_mov_b64 exec, s[8:9]
    ds_read_b128 v[124:127], v4 offset:36864
    ds_read_b128 v[128:131], v4 offset:37440
    s_mov_b64 exec, -1
    v_cvt_pk_bf16_f32 v68, v36, v37
    v_cvt_pk_bf16_f32 v69, v38, v39
    v_exp_f32 v40, v40
    v_exp_f32 v41, v41
    v_exp_f32 v42, v42
    v_exp_f32 v43, v43
    v_mfma_f32_32x32x16_bf16 v[52:67], v[112:115], v[32:35], v[52:67]
    ds_read_b128 v[112:115], v2 offset:37888
    v_cvt_pk_bf16_f32 v70, v40, v41
    v_cvt_pk_bf16_f32 v71, v42, v43
    v_exp_f32 v44, v44
    v_exp_f32 v45, v45
    v_exp_f32 v46, v46
    v_exp_f32 v47, v47
    v_mfma_f32_32x32x16_bf16 v[76:91], v[132:135], v[68:71], v[76:91]
    v_cvt_pk_bf16_f32 v72, v44, v45
    v_cvt_pk_bf16_f32 v73, v46, v47
    v_exp_f32 v48, v48
    v_exp_f32 v49, v49
    v_exp_f32 v50, v50
    v_exp_f32 v51, v51
    v_cvt_pk_bf16_f32 v74, v48, v49
    v_cvt_pk_bf16_f32 v75, v50, v51
    v_mfma_f32_32x32x8_bf16 v[36:51], v[116:117], v[12:13], 0
    v_exp_f32 v52, v52
    v_exp_f32 v53, v53
    v_exp_f32 v54, v54
    v_exp_f32 v55, v55
    v_mfma_f32_32x32x16_bf16 v[76:91], v[136:139], v[72:75], v[76:91]
    v_cvt_pk_bf16_f32 v68, v52, v53
    v_cvt_pk_bf16_f32 v69, v54, v55
    v_exp_f32 v56, v56
    v_exp_f32 v57, v57
    v_exp_f32 v58, v58
    v_exp_f32 v59, v59
    v_mfma_f32_32x32x16_bf16 v[36:51], v[108:111], v[28:31], v[36:51]
    v_cvt_pk_bf16_f32 v70, v56, v57
    v_cvt_pk_bf16_f32 v71, v58, v59
    v_exp_f32 v60, v60
    v_exp_f32 v61, v61
    v_exp_f32 v62, v62
    v_exp_f32 v63, v63
    v_mfma_f32_32x32x16_bf16 v[92:107], v[132:135], v[68:71], v[92:107]
    v_cvt_pk_bf16_f32 v72, v60, v61
    v_cvt_pk_bf16_f32 v73, v62, v63
    v_exp_f32 v64, v64
    v_exp_f32 v65, v65
    v_exp_f32 v66, v66
    v_exp_f32 v67, v67
    v_cvt_pk_bf16_f32 v74, v64, v65
    v_cvt_pk_bf16_f32 v75, v66, v67
L_a_loop_end:
    v_add_u32 v2, 36864, v2
    v_add_u32 v4, 36864, v4
    s_add_u32 s48, s48, 1
    s_cmp_eq_u32 s48, s59
    s_cbranch_scc1 L_a_inter
    s_cmp_lt_u32 s48, 4
    s_cbranch_scc1 L_a_loop
    v_mfma_f32_32x32x16_bf16 v[92:107], v[136:139], v[72:75], v[92:107]
    s_lshl_b32 s46, s3, 2
    s_add_u32 s46, s46, 163368
    s_xor_b32 s47, s46, 4
    v_mov_b32 v8, s47
    v_mov_b32 v9, 1
    s_nop 6
    v_cndmask_b32 v5, v102, v86, s[50:51]
    ds_write_b32 v3, v5
    ds_write_b32 v8, v9
    v_mov_b32 v8, s46
    v_and_b32 v3, 31, v1
    v_lshl_add_u32 v3, v3, 2, s14
    v_bfe_u32 v6, v1, 4, 1
    v_mul_u32_u24 v6, 576, v6
    v_add_u32 v6, s14, v6
    v_and_b32 v7, 15, v1
    v_lshl_add_u32 v36, v7, 2, v6
    v_lshl_add_u32 v6, v7, 5, v6
    v_lshrrev_b32 v7, 5, v1
    v_lshl_add_u32 v37, v7, 4, v6
    v_and_b32 v5, 15, v1
    v_mul_u32_u24 v7, 576, v5
    v_and_b32 v5, 7, v1
    v_lshrrev_b32 v6, 4, v1
    v_lshl_add_u32 v7, v6, 4, v7
    v_add_u32 v39, 147456, v7
    v_lshl_add_u32 v7, v6, 3, v5
    s_mul_i32 s46, s40, 1536
    s_add_u32 s46, s46, 156672
    v_lshl_add_u32 v40, v7, 4, s46
    s_cmp_lg_u32 s41, 0
    s_cbranch_scc1 L_a_noearly
    v_lshlrev_b32 v9, 4, v1
    s_mul_i32 s61, s40, 9216
    s_add_u32 s61, s61, 184320
    buffer_load_dwordx4 v[148:151], v9, s[32:35], s61 offen offset:0 sc1
    buffer_load_dwordx4 v[152:155], v9, s[32:35], s61 offen offset:1024 sc1
    buffer_load_dwordx4 v[156:159], v9, s[32:35], s61 offen offset:2048 sc1
    buffer_load_dwordx4 v[160:163], v9, s[32:35], s61 offen offset:3072 sc1
    s_add_u32 s61, s61, 4096
    buffer_load_dwordx4 v[164:167], v9, s[32:35], s61 offen offset:0 sc1
    buffer_load_dwordx4 v[168:171], v9, s[32:35], s61 offen offset:1024 sc1
    buffer_load_dwordx4 v[172:175], v9, s[32:35], s61 offen offset:2048 sc1
    buffer_load_dwordx4 v[176:179], v9, s[32:35], s61 offen offset:3072 sc1
    s_add_u32 s61, s61, 4096
    buffer_load_dwordx4 v[180:183], v9, s[32:35], s61 offen offset:0 sc1
    s_add_u32 s61, s61, 28672
    buffer_load_dwordx4 v[184:187], v9, s[32:35], s61 offen offset:0 sc1
    buffer_load_dwordx4 v[188:191], v9, s[32:35], s61 offen offset:1024 sc1
    buffer_load_dwordx4 v[192:195], v9, s[32:35], s61 offen offset:2048 sc1
    buffer_load_dwordx4 v[196:199], v9, s[32:35], s61 offen offset:3072 sc1
    s_add_u32 s61, s61, 4096
    buffer_load_dwordx4 v[200:203], v9, s[32:35], s61 offen offset:0 sc1
    buffer_load_dwordx4 v[204:207], v9, s[32:35], s61 offen offset:1024 sc1
    buffer_load_dwordx4 v[208:211], v9, s[32:35], s61 offen offset:2048 sc1
    buffer_load_dwordx4 v[212:215], v9, s[32:35], s61 offen offset:3072 sc1
    s_add_u32 s61, s61, 4096
    buffer_load_dwordx4 v[216:219], v9, s[32:35], s61 offen offset:0 sc1
    s_add_u32 s61, s61, 28672
    buffer_load_dwordx4 v[220:223], v9, s[32:35], s61 offen offset:0 sc1
    buffer_load_dwordx4 v[224:227], v9, s[32:35], s61 offen offset:1024 sc1
    buffer_load_dwordx4 v[228:231], v9, s[32:35], s61 offen offset:2048 sc1
    buffer_load_dwordx4 v[232:235], v9, s[32:35], s61 offen offset:3072 sc1
    s_add_u32 s61, s61, 4096
    buffer_load_dwordx4 v[236:239], v9, s[32:35], s61 offen offset:0 sc1
    buffer_load_dwordx4 v[240:243], v9, s[32:35], s61 offen offset:1024 sc1
    buffer_load_dwordx4 v[244:247], v9, s[32:35], s61 offen offset:2048 sc1
    buffer_load_dwordx4 v[248:251], v9, s[32:35], s61 offen offset:3072 sc1
    s_add_u32 s61, s61, 4096
    buffer_load_dwordx4 v[252:255], v9, s[32:35], s61 offen offset:0 sc1
    s_add_u32 s61, s61, 28672
L_a_noearly:
    s_mov_b32 s49, 65536
L_a_lpoll:
    ds_read_b32 v5, v8
    ds_read2_b32 v[6:7], v3 offset0:0 offset1:32
    s_waitcnt lgkmcnt(0)
    v_readfirstlane_b32 s46, v5
    s_sub_u32 s49, s49, 1
    s_cbranch_scc1 L_a_lok
    s_cmp_eq_u32 s46, 0
    s_cbranch_scc1 L_a_lpoll
L_a_lok:
    v_add_f32 v6, v6, v86
    v_add_f32 v7, v7, v102
    v_min_f32 v5, v6, v7
    v_add_f32 v8, v6, v7
    v_mov_b32 v9, 0x2b800000
    v_cmp_nge_f32 vcc, v5, v9
    v_cmp_u_f32 s[46:47], v8, v8
    v_rcp_f32 v6, v6
    v_rcp_f32 v7, v7
    s_or_b64 vcc, vcc, s[46:47]
    s_cbranch_scc1 L_a_fallback
L_a_norm:
    v_mul_f32 v76, v76, v6
    v_mul_f32 v77, v77, v6
    v_mul_f32 v78, v78, v6
    v_mul_f32 v79, v79, v6
    v_mul_f32 v80, v80, v6
    v_mul_f32 v81, v81, v6
    v_mul_f32 v82, v82, v6
    v_mul_f32 v83, v83, v6
    v_mul_f32 v84, v84, v6
    v_mul_f32 v85, v85, v6
    v_cvt_pk_bf16_f32 v52, v76, v77
    v_cvt_pk_bf16_f32 v53, v78, v79
    v_cvt_pk_bf16_f32 v54, v80, v81
    v_cvt_pk_bf16_f32 v55, v82, v83
    v_cvt_pk_bf16_f32 v56, v84, v85
    ds_write_b128 v37, v[52:55] offset:0
    v_mul_f32 v92, v92, v7
    v_mul_f32 v93, v93, v7
    v_mul_f32 v94, v94, v7
    v_mul_f32 v95, v95, v7
    v_mul_f32 v96, v96, v7
    v_mul_f32 v97, v97, v7
    v_mul_f32 v98, v98, v7
    v_mul_f32 v99, v99, v7
    v_mul_f32 v100, v100, v7
    v_mul_f32 v101, v101, v7
    v_cvt_pk_bf16_f32 v60, v92, v93
    v_cvt_pk_bf16_f32 v61, v94, v95
    v_cvt_pk_bf16_f32 v62, v96, v97
    v_cvt_pk_bf16_f32 v63, v98, v99
    v_cvt_pk_bf16_f32 v64, v100, v101
    ds_write_b128 v37, v[60:63] offset:1152
    s_mov_b64 exec, s[50:51]
    ds_write_b32 v36, v56 offset:512
    ds_write_b32 v36, v64 offset:1664
    s_mov_b64 exec, -1
    v_mov_b32 v3, v40
    v_mov_b32 v4, v39
    v_and_b32 v5, 7, v1
    v_lshrrev_b32 v6, 4, v1
    v_lshlrev_b32 v2, 4, v1
    s_cmp_lg_u32 s41, 0
    s_cbranch_scc1 L_a_young_tail
    v_mov_b32 v8, 163328
    v_mov_b32 v9, 1
    s_waitcnt lgkmcnt(0)
    s_mov_b64 exec, 1
    ds_add_u32 v8, v9
    s_mov_b64 exec, -1
    buffer_load_dwordx4 v[112:115], v2, s[32:35], s61 offen offset:0 sc1
    buffer_load_dwordx4 v[116:119], v2, s[32:35], s61 offen offset:1024 sc1
    buffer_load_dwordx4 v[120:123], v2, s[32:35], s61 offen offset:2048 sc1
    buffer_load_dwordx4 v[124:127], v2, s[32:35], s61 offen offset:3072 sc1
    s_add_u32 s61, s61, 4096
    buffer_load_dwordx4 v[128:131], v2, s[32:35], s61 offen offset:0 sc1
    buffer_load_dwordx4 v[132:135], v2, s[32:35], s61 offen offset:1024 sc1
    buffer_load_dwordx4 v[136:139], v2, s[32:35], s61 offen offset:2048 sc1
    buffer_load_dwordx4 v[140:143], v2, s[32:35], s61 offen offset:3072 sc1
    s_add_u32 s61, s61, 4096
    buffer_load_dwordx4 v[144:147], v2, s[32:35], s61 offen offset:0 sc1
    s_add_u32 s61, s61, 28672
    v_mul_u32_u24 v10, 1152, v5
    v_lshl_add_u32 v11, v6, 3, v10
    v_lshl_add_u32 v10, v6, 4, v10
    s_mul_i32 s46, s42, 1152
    s_mul_i32 s47, s40, 288
    s_add_u32 s52, s46, s47
    s_mov_b64 exec, s[54:55]
    buffer_load_dwordx4 v[92:95], v10, s[36:39], s52 offen offset:0
    buffer_load_dwordx4 v[96:99], v10, s[36:39], s52 offen offset:64
    buffer_load_dwordx4 v[100:103], v10, s[36:39], s52 offen offset:128
    buffer_load_dwordx4 v[104:107], v10, s[36:39], s52 offen offset:192
    buffer_load_dwordx2 v[108:109], v11, s[36:39], s52 offen offset:256
    s_mov_b64 exec, -1
    s_mul_i32 s62, s40, 9216
    s_add_u32 s62, s62, 516096
    s_mov_b32 s49, 16384
L_a_poll:
    ds_read_b32 v9, v8
    s_waitcnt lgkmcnt(0)
    v_readfirstlane_b32 s47, v9
    s_sub_u32 s49, s49, 1
    s_cbranch_scc1 L_a_poll_ok
    s_cmp_ge_u32 s47, 4
    s_cbranch_scc1 L_a_poll_ok
    s_sleep 2
    s_branch L_a_poll
L_a_poll_ok:
    ds_read_b128 v[56:59], v4 offset:0
    ds_read_b128 v[60:63], v4 offset:64
    ds_read_b128 v[64:67], v4 offset:128
    ds_read_b128 v[68:71], v4 offset:192
    ds_read_b128 v[72:75], v4 offset:256
    ds_read_b128 v[76:79], v4 offset:320
    ds_read_b128 v[80:83], v4 offset:384
    ds_read_b128 v[84:87], v4 offset:448
    ds_read_b128 v[88:91], v4 offset:512
    v_mov_b32 v9, 1
    s_waitcnt lgkmcnt(0)
    s_mov_b64 exec, 1
    ds_add_u32 v8, v9
    s_mov_b64 exec, -1
    v_mov_b32 v8, 163348
    s_mov_b32 s49, 16384
L_a_pkl:
    ds_read_b32 v9, v8
    s_waitcnt lgkmcnt(0)
    v_readfirstlane_b32 s47, v9
    s_sub_u32 s49, s49, 1
    s_cbranch_scc1 L_a_pkl_ok
    s_cmp_ge_u32 s47, 4
    s_cbranch_scc1 L_a_pkl_ok
    s_sleep 2
    s_branch L_a_pkl
L_a_pkl_ok:
    v_mov_b32 v8, 0
    v_mov_b32 v9, s30
    s_lshl_b32 s46, s43, 5
    s_add_u32 s46, s46, s56
    s_lshl_b32 s46, s46, 5
    s_add_u32 s46, s46, 884736
    s_cmp_eq_u32 s40, 0
    s_cselect_b32 s46, s46, -1
    s_mov_b64 exec, 1
    buffer_store_dword v9, v8, s[32:35], s46 offen sc1
    s_mov_b64 exec, -1
    s_setprio 0
    s_waitcnt vmcnt(33)
    v_mfma_f32_16x16x32_bf16 v[16:19], v[148:151], v[56:59], 0
    v_mfma_f32_16x16x32_bf16 v[20:23], v[152:155], v[56:59], 0
    v_mfma_f32_16x16x32_bf16 v[24:27], v[156:159], v[56:59], 0
    v_mfma_f32_16x16x32_bf16 v[28:31], v[160:163], v[56:59], 0
    v_mfma_f32_16x16x32_bf16 v[32:35], v[164:167], v[56:59], 0
    v_mfma_f32_16x16x32_bf16 v[36:39], v[168:171], v[56:59], 0
    v_mfma_f32_16x16x32_bf16 v[40:43], v[172:175], v[56:59], 0
    v_mfma_f32_16x16x32_bf16 v[44:47], v[176:179], v[56:59], 0
    v_mfma_f32_16x16x32_bf16 v[48:51], v[180:183], v[56:59], 0
    buffer_load_dwordx4 v[148:151], v2, s[32:35], s61 offen offset:0 sc1
    buffer_load_dwordx4 v[152:155], v2, s[32:35], s61 offen offset:1024 sc1
    buffer_load_dwordx4 v[156:159], v2, s[32:35], s61 offen offset:2048 sc1
    buffer_load_dwordx4 v[160:163], v2, s[32:35], s61 offen offset:3072 sc1
    s_add_u32 s61, s61, 4096
    buffer_load_dwordx4 v[164:167], v2, s[32:35], s61 offen offset:0 sc1
    buffer_load_dwordx4 v[168:171], v2, s[32:35], s61 offen offset:1024 sc1
    buffer_load_dwordx4 v[172:175], v2, s[32:35], s61 offen offset:2048 sc1
    buffer_load_dwordx4 v[176:179], v2, s[32:35], s61 offen offset:3072 sc1
    s_add_u32 s61, s61, 4096
    buffer_load_dwordx4 v[180:183], v2, s[32:35], s61 offen offset:0 sc1
    s_add_u32 s61, s61, 28672
    s_waitcnt vmcnt(33)
    v_mfma_f32_16x16x32_bf16 v[16:19], v[184:187], v[60:63], v[16:19]
    v_mfma_f32_16x16x32_bf16 v[20:23], v[188:191], v[60:63], v[20:23]
    v_mfma_f32_16x16x32_bf16 v[24:27], v[192:195], v[60:63], v[24:27]
    v_mfma_f32_16x16x32_bf16 v[28:31], v[196:199], v[60:63], v[28:31]
    v_mfma_f32_16x16x32_bf16 v[32:35], v[200:203], v[60:63], v[32:35]
    v_mfma_f32_16x16x32_bf16 v[36:39], v[204:207], v[60:63], v[36:39]
    v_mfma_f32_16x16x32_bf16 v[40:43], v[208:211], v[60:63], v[40:43]
    v_mfma_f32_16x16x32_bf16 v[44:47], v[212:215], v[60:63], v[44:47]
    v_mfma_f32_16x16x32_bf16 v[48:51], v[216:219], v[60:63], v[48:51]
    buffer_load_dwordx4 v[184:187], v2, s[32:35], s61 offen offset:0 sc1
    buffer_load_dwordx4 v[188:191], v2, s[32:35], s61 offen offset:1024 sc1
    buffer_load_dwordx4 v[192:195], v2, s[32:35], s61 offen offset:2048 sc1
    buffer_load_dwordx4 v[196:199], v2, s[32:35], s61 offen offset:3072 sc1
    s_add_u32 s61, s61, 4096
    buffer_load_dwordx4 v[200:203], v2, s[32:35], s61 offen offset:0 sc1
    buffer_load_dwordx4 v[204:207], v2, s[32:35], s61 offen offset:1024 sc1
    buffer_load_dwordx4 v[208:211], v2, s[32:35], s61 offen offset:2048 sc1
    buffer_load_dwordx4 v[212:215], v2, s[32:35], s61 offen offset:3072 sc1
    s_add_u32 s61, s61, 4096
    buffer_load_dwordx4 v[216:219], v2, s[32:35], s61 offen offset:0 sc1
    s_add_u32 s61, s61, 28672
    s_waitcnt vmcnt(33)
    v_mfma_f32_16x16x32_bf16 v[16:19], v[220:223], v[64:67], v[16:19]
    v_mfma_f32_16x16x32_bf16 v[20:23], v[224:227], v[64:67], v[20:23]
    v_mfma_f32_16x16x32_bf16 v[24:27], v[228:231], v[64:67], v[24:27]
    v_mfma_f32_16x16x32_bf16 v[28:31], v[232:235], v[64:67], v[28:31]
    v_mfma_f32_16x16x32_bf16 v[32:35], v[236:239], v[64:67], v[32:35]
    v_mfma_f32_16x16x32_bf16 v[36:39], v[240:243], v[64:67], v[36:39]
    v_mfma_f32_16x16x32_bf16 v[40:43], v[244:247], v[64:67], v[40:43]
    v_mfma_f32_16x16x32_bf16 v[44:47], v[248:251], v[64:67], v[44:47]
    v_mfma_f32_16x16x32_bf16 v[48:51], v[252:255], v[64:67], v[48:51]
    buffer_load_dwordx4 v[220:223], v2, s[32:35], s61 offen offset:0 sc1
    buffer_load_dwordx4 v[224:227], v2, s[32:35], s61 offen offset:1024 sc1
    buffer_load_dwordx4 v[228:231], v2, s[32:35], s61 offen offset:2048 sc1
    buffer_load_dwordx4 v[232:235], v2, s[32:35], s61 offen offset:3072 sc1
    s_add_u32 s61, s61, 4096
    buffer_load_dwordx4 v[236:239], v2, s[32:35], s61 offen offset:0 sc1
    buffer_load_dwordx4 v[240:243], v2, s[32:35], s61 offen offset:1024 sc1
    buffer_load_dwordx4 v[244:247], v2, s[32:35], s61 offen offset:2048 sc1
    buffer_load_dwordx4 v[248:251], v2, s[32:35], s61 offen offset:3072 sc1
    s_add_u32 s61, s61, 4096
    buffer_load_dwordx4 v[252:255], v2, s[32:35], s61 offen offset:0 sc1
    s_add_u32 s61, s61, 28672
    s_waitcnt vmcnt(33)
    v_mfma_f32_16x16x32_bf16 v[16:19], v[112:115], v[68:71], v[16:19]
    v_mfma_f32_16x16x32_bf16 v[20:23], v[116:119], v[68:71], v[20:23]
    v_mfma_f32_16x16x32_bf16 v[24:27], v[120:123], v[68:71], v[24:27]
    v_mfma_f32_16x16x32_bf16 v[28:31], v[124:127], v[68:71], v[28:31]
    v_mfma_f32_16x16x32_bf16 v[32:35], v[128:131], v[68:71], v[32:35]
    v_mfma_f32_16x16x32_bf16 v[36:39], v[132:135], v[68:71], v[36:39]
    v_mfma_f32_16x16x32_bf16 v[40:43], v[136:139], v[68:71], v[40:43]
    v_mfma_f32_16x16x32_bf16 v[44:47], v[140:143], v[68:71], v[44:47]
    v_mfma_f32_16x16x32_bf16 v[48:51], v[144:147], v[68:71], v[48:51]
    buffer_load_dwordx4 v[112:115], v2, s[32:35], s61 offen offset:0 sc1
    buffer_load_dwordx4 v[116:119], v2, s[32:35], s61 offen offset:1024 sc1
    buffer_load_dwordx4 v[120:123], v2, s[32:35], s61 offen offset:2048 sc1
    buffer_load_dwordx4 v[124:127], v2, s[32:35], s61 offen offset:3072 sc1
    s_add_u32 s61, s61, 4096
    buffer_load_dwordx4 v[128:131], v2, s[32:35], s61 offen offset:0 sc1
    buffer_load_dwordx4 v[132:135], v2, s[32:35], s61 offen offset:1024 sc1
    buffer_load_dwordx4 v[136:139], v2, s[32:35], s61 offen offset:2048 sc1
    buffer_load_dwordx4 v[140:143], v2, s[32:35], s61 offen offset:3072 sc1
    s_add_u32 s61, s61, 4096
    buffer_load_dwordx4 v[144:147], v2, s[32:35], s61 offen offset:0 sc1
    s_add_u32 s61, s61, 28672
    s_waitcnt vmcnt(27)
    v_mfma_f32_16x16x32_bf16 v[16:19], v[148:151], v[72:75], v[16:19]
    v_mfma_f32_16x16x32_bf16 v[20:23], v[152:155], v[72:75], v[20:23]
    v_mfma_f32_16x16x32_bf16 v[24:27], v[156:159], v[72:75], v[24:27]
    v_mfma_f32_16x16x32_bf16 v[28:31], v[160:163], v[72:75], v[28:31]
    v_mfma_f32_16x16x32_bf16 v[32:35], v[164:167], v[72:75], v[32:35]
    v_mfma_f32_16x16x32_bf16 v[36:39], v[168:171], v[72:75], v[36:39]
    v_mfma_f32_16x16x32_bf16 v[40:43], v[172:175], v[72:75], v[40:43]
    v_mfma_f32_16x16x32_bf16 v[44:47], v[176:179], v[72:75], v[44:47]
    v_mfma_f32_16x16x32_bf16 v[48:51], v[180:183], v[72:75], v[48:51]
    buffer_load_dwordx4 v[148:151], v2, s[32:35], s61 offen offset:0 sc1
    buffer_load_dwordx4 v[152:155], v2, s[32:35], s61 offen offset:1024 sc1
    buffer_load_dwordx4 v[156:159], v2, s[32:35], s61 offen offset:2048 sc1
    buffer_load_dwordx4 v[160:163], v2, s[32:35], s61 offen offset:3072 sc1
    s_add_u32 s61, s61, 4096
    buffer_load_dwordx4 v[164:167], v2, s[32:35], s61 offen offset:0 sc1
    buffer_load_dwordx4 v[168:171], v2, s[32:35], s61 offen offset:1024 sc1
    buffer_load_dwordx4 v[172:175], v2, s[32:35], s61 offen offset:2048 sc1
    buffer_load_dwordx4 v[176:179], v2, s[32:35], s61 offen offset:3072 sc1
    s_add_u32 s61, s61, 4096
    buffer_load_dwordx4 v[180:183], v2, s[32:35], s61 offen offset:0 sc1
    s_add_u32 s61, s61, 28672
    s_waitcnt vmcnt(27)
    v_mfma_f32_16x16x32_bf16 v[16:19], v[184:187], v[76:79], v[16:19]
    v_mfma_f32_16x16x32_bf16 v[20:23], v[188:191], v[76:79], v[20:23]
    v_mfma_f32_16x16x32_bf16 v[24:27], v[192:195], v[76:79], v[24:27]
    v_mfma_f32_16x16x32_bf16 v[28:31], v[196:199], v[76:79], v[28:31]
    v_mfma_f32_16x16x32_bf16 v[32:35], v[200:203], v[76:79], v[32:35]
    v_mfma_f32_16x16x32_bf16 v[36:39], v[204:207], v[76:79], v[36:39]
    v_mfma_f32_16x16x32_bf16 v[40:43], v[208:211], v[76:79], v[40:43]
    v_mfma_f32_16x16x32_bf16 v[44:47], v[212:215], v[76:79], v[44:47]
    v_mfma_f32_16x16x32_bf16 v[48:51], v[216:219], v[76:79], v[48:51]
    s_add_u32 s46, s62, 0
    buffer_load_dwordx4 v[184:187], v2, s[32:35], s46 offen offset:0 sc1
    buffer_load_dwordx4 v[188:191], v2, s[32:35], s46 offen offset:1024 sc1
    buffer_load_dwordx4 v[192:195], v2, s[32:35], s46 offen offset:2048 sc1
    s_add_u32 s46, s62, 3072
    buffer_load_dwordx4 v[196:199], v2, s[32:35], s46 offen offset:0 sc1
    buffer_load_dwordx4 v[200:203], v2, s[32:35], s46 offen offset:1024 sc1
    buffer_load_dwordx4 v[204:207], v2, s[32:35], s46 offen offset:2048 sc1
    s_add_u32 s46, s62, 36864
    buffer_load_dwordx4 v[208:211], v2, s[32:35], s46 offen offset:0 sc1
    buffer_load_dwordx4 v[212:215], v2, s[32:35], s46 offen offset:1024 sc1
    buffer_load_dwordx4 v[216:219], v2, s[32:35], s46 offen offset:2048 sc1
    s_waitcnt vmcnt(27)
    v_mfma_f32_16x16x32_bf16 v[16:19], v[220:223], v[80:83], v[16:19]
    v_mfma_f32_16x16x32_bf16 v[20:23], v[224:227], v[80:83], v[20:23]
    v_mfma_f32_16x16x32_bf16 v[24:27], v[228:231], v[80:83], v[24:27]
    v_mfma_f32_16x16x32_bf16 v[28:31], v[232:235], v[80:83], v[28:31]
    v_mfma_f32_16x16x32_bf16 v[32:35], v[236:239], v[80:83], v[32:35]
    v_mfma_f32_16x16x32_bf16 v[36:39], v[240:243], v[80:83], v[36:39]
    v_mfma_f32_16x16x32_bf16 v[40:43], v[244:247], v[80:83], v[40:43]
    v_mfma_f32_16x16x32_bf16 v[44:47], v[248:251], v[80:83], v[44:47]
    v_mfma_f32_16x16x32_bf16 v[48:51], v[252:255], v[80:83], v[48:51]
    s_add_u32 s46, s62, 39936
    buffer_load_dwordx4 v[220:223], v2, s[32:35], s46 offen offset:0 sc1
    buffer_load_dwordx4 v[224:227], v2, s[32:35], s46 offen offset:1024 sc1
    buffer_load_dwordx4 v[228:231], v2, s[32:35], s46 offen offset:2048 sc1
    s_add_u32 s46, s62, 73728
    buffer_load_dwordx4 v[232:235], v2, s[32:35], s46 offen offset:0 sc1
    buffer_load_dwordx4 v[236:239], v2, s[32:35], s46 offen offset:1024 sc1
    buffer_load_dwordx4 v[240:243], v2, s[32:35], s46 offen offset:2048 sc1
    s_add_u32 s46, s62, 76800
    buffer_load_dwordx4 v[244:247], v2, s[32:35], s46 offen offset:0 sc1
    buffer_load_dwordx4 v[248:251], v2, s[32:35], s46 offen offset:1024 sc1
    buffer_load_dwordx4 v[252:255], v2, s[32:35], s46 offen offset:2048 sc1
    s_waitcnt vmcnt(27)
    v_mfma_f32_16x16x32_bf16 v[16:19], v[112:115], v[84:87], v[16:19]
    v_mfma_f32_16x16x32_bf16 v[20:23], v[116:119], v[84:87], v[20:23]
    v_mfma_f32_16x16x32_bf16 v[24:27], v[120:123], v[84:87], v[24:27]
    v_mfma_f32_16x16x32_bf16 v[28:31], v[124:127], v[84:87], v[28:31]
    v_mfma_f32_16x16x32_bf16 v[32:35], v[128:131], v[84:87], v[32:35]
    v_mfma_f32_16x16x32_bf16 v[36:39], v[132:135], v[84:87], v[36:39]
    v_mfma_f32_16x16x32_bf16 v[40:43], v[136:139], v[84:87], v[40:43]
    v_mfma_f32_16x16x32_bf16 v[44:47], v[140:143], v[84:87], v[44:47]
    v_mfma_f32_16x16x32_bf16 v[48:51], v[144:147], v[84:87], v[48:51]
    s_add_u32 s46, s62, 110592
    buffer_load_dwordx4 v[112:115], v2, s[32:35], s46 offen offset:0 sc1
    buffer_load_dwordx4 v[116:119], v2, s[32:35], s46 offen offset:1024 sc1
    buffer_load_dwordx4 v[120:123], v2, s[32:35], s46 offen offset:2048 sc1
    s_add_u32 s46, s62, 113664
    buffer_load_dwordx4 v[124:127], v2, s[32:35], s46 offen offset:0 sc1
    buffer_load_dwordx4 v[128:131], v2, s[32:35], s46 offen offset:1024 sc1
    buffer_load_dwordx4 v[132:135], v2, s[32:35], s46 offen offset:2048 sc1
    s_add_u32 s46, s62, 147456
    buffer_load_dwordx4 v[136:139], v2, s[32:35], s46 offen offset:0 sc1
    buffer_load_dwordx4 v[140:143], v2, s[32:35], s46 offen offset:1024 sc1
    buffer_load_dwordx4 v[144:147], v2, s[32:35], s46 offen offset:2048 sc1
    s_waitcnt vmcnt(27)
    v_mfma_f32_16x16x32_bf16 v[16:19], v[148:151], v[88:91], v[16:19]
    v_mfma_f32_16x16x32_bf16 v[20:23], v[152:155], v[88:91], v[20:23]
    v_mfma_f32_16x16x32_bf16 v[24:27], v[156:159], v[88:91], v[24:27]
    v_mfma_f32_16x16x32_bf16 v[28:31], v[160:163], v[88:91], v[28:31]
    v_mfma_f32_16x16x32_bf16 v[32:35], v[164:167], v[88:91], v[32:35]
    v_mfma_f32_16x16x32_bf16 v[36:39], v[168:171], v[88:91], v[36:39]
    v_mfma_f32_16x16x32_bf16 v[40:43], v[172:175], v[88:91], v[40:43]
    v_mfma_f32_16x16x32_bf16 v[44:47], v[176:179], v[88:91], v[44:47]
    v_mfma_f32_16x16x32_bf16 v[48:51], v[180:183], v[88:91], v[48:51]
    s_add_u32 s46, s62, 150528
    buffer_load_dwordx4 v[148:151], v2, s[32:35], s46 offen offset:0 sc1
    buffer_load_dwordx4 v[152:155], v2, s[32:35], s46 offen offset:1024 sc1
    buffer_load_dwordx4 v[156:159], v2, s[32:35], s46 offen offset:2048 sc1
    s_add_u32 s46, s62, 184320
    buffer_load_dwordx4 v[160:163], v2, s[32:35], s46 offen offset:0 sc1
    buffer_load_dwordx4 v[164:167], v2, s[32:35], s46 offen offset:1024 sc1
    buffer_load_dwordx4 v[168:171], v2, s[32:35], s46 offen offset:2048 sc1
    s_add_u32 s46, s62, 187392
    buffer_load_dwordx4 v[172:175], v2, s[32:35], s46 offen offset:0 sc1
    buffer_load_dwordx4 v[176:179], v2, s[32:35], s46 offen offset:1024 sc1
    buffer_load_dwordx4 v[180:183], v2, s[32:35], s46 offen offset:2048 sc1
    s_setprio 2
    s_mov_b32 s46, 0x00003f80
    s_mov_b32 s47, 0x3f800000
    v_add_f32_dpp v40, v40, v40 row_ror:8 row_mask:0xf bank_mask:0xf
    v_add_f32_dpp v41, v41, v41 row_ror:8 row_mask:0xf bank_mask:0xf
    v_add_f32_dpp v42, v42, v42 row_ror:8 row_mask:0xf bank_mask:0xf
    v_add_f32_dpp v43, v43, v43 row_ror:8 row_mask:0xf bank_mask:0xf
    v_add_f32_dpp v44, v44, v44 row_ror:8 row_mask:0xf bank_mask:0xf
    v_add_f32_dpp v45, v45, v45 row_ror:8 row_mask:0xf bank_mask:0xf
    v_add_f32_dpp v46, v46, v46 row_ror:8 row_mask:0xf bank_mask:0xf
    v_add_f32_dpp v47, v47, v47 row_ror:8 row_mask:0xf bank_mask:0xf
    v_add_f32_dpp v48, v48, v48 row_ror:8 row_mask:0xf bank_mask:0xf
    v_add_f32_dpp v49, v49, v49 row_ror:8 row_mask:0xf bank_mask:0xf
    v_add_f32_dpp v50, v50, v50 row_ror:8 row_mask:0xf bank_mask:0xf
    v_add_f32_dpp v51, v51, v51 row_ror:8 row_mask:0xf bank_mask:0xf
    s_mov_b64 exec, s[54:55]
    v_dot2_f32_bf16 v40, v104, s46, v40
    v_dot2_f32_bf16 v41, v104, s47, v41
    v_dot2_f32_bf16 v42, v105, s46, v42
    v_dot2_f32_bf16 v43, v105, s47, v43
    v_dot2_f32_bf16 v44, v106, s46, v44
    v_dot2_f32_bf16 v45, v106, s47, v45
    v_dot2_f32_bf16 v46, v107, s46, v46
    v_dot2_f32_bf16 v47, v107, s47, v47
    v_dot2_f32_bf16 v48, v108, s46, v48
    v_dot2_f32_bf16 v49, v108, s47, v49
    v_dot2_f32_bf16 v50, v109, s46, v50
    v_dot2_f32_bf16 v51, v109, s47, v51
    v_dot2_f32_bf16 v16, v92, s46, v16
    v_dot2_f32_bf16 v17, v92, s47, v17
    v_dot2_f32_bf16 v18, v93, s46, v18
    v_dot2_f32_bf16 v19, v93, s47, v19
    v_dot2_f32_bf16 v20, v94, s46, v20
    v_dot2_f32_bf16 v21, v94, s47, v21
    v_dot2_f32_bf16 v22, v95, s46, v22
    v_dot2_f32_bf16 v23, v95, s47, v23
    v_dot2_f32_bf16 v24, v96, s46, v24
    v_dot2_f32_bf16 v25, v96, s47, v25
    v_dot2_f32_bf16 v26, v97, s46, v26
    v_dot2_f32_bf16 v27, v97, s47, v27
    v_dot2_f32_bf16 v28, v98, s46, v28
    v_dot2_f32_bf16 v29, v98, s47, v29
    v_dot2_f32_bf16 v30, v99, s46, v30
    v_dot2_f32_bf16 v31, v99, s47, v31
    v_dot2_f32_bf16 v32, v100, s46, v32
    v_dot2_f32_bf16 v33, v100, s47, v33
    v_dot2_f32_bf16 v34, v101, s46, v34
    v_dot2_f32_bf16 v35, v101, s47, v35
    v_dot2_f32_bf16 v36, v102, s46, v36
    v_dot2_f32_bf16 v37, v102, s47, v37
    v_dot2_f32_bf16 v38, v103, s46, v38
    v_dot2_f32_bf16 v39, v103, s47, v39
    s_mov_b64 exec, -1
    s_mov_b64 exec, s[54:55]
    ds_write_b128 v3, v[40:43] offset:0
    ds_write_b128 v3, v[44:47] offset:512
    ds_write_b128 v3, v[48:51] offset:1024
    s_mov_b64 exec, -1
    s_waitcnt lgkmcnt(0)
    v_and_b32 v8, 31, v1
    v_lshlrev_b32 v8, 5, v8
    s_lshl_b32 s46, s43, 10
    s_add_u32 s46, s46, 884736
    s_mov_b32 s49, 16384
L_a_pkpoll:
    buffer_load_dword v10, v8, s[32:35], s46 offen sc1
    s_waitcnt vmcnt(0)
    v_cmp_ne_u32 vcc, s30, v10
    s_sub_u32 s49, s49, 1
    s_cbranch_scc1 L_a_pkpoll_ok
    s_nop 1
    s_cmp_eq_u64 vcc, 0
    s_cbranch_scc1 L_a_pkpoll_ok
    s_sleep 8
    s_branch L_a_pkpoll
L_a_pkpoll_ok:
    s_lshr_b32 s46, s56, 1
    s_and_b32 s46, s46, 15
    s_lshr_b32 s47, s46, 1
    s_mul_i32 s47, s47, 165888
    s_and_b32 s46, s46, 1
    s_lshl_b32 s46, s46, 2
    s_add_u32 s46, s46, s40
    s_lshl_b32 s46, s46, 12
    s_add_u32 s46, s46, s47
    s_mul_i32 s47, s43, 1327104
    s_add_u32 s46, s46, s47
    s_add_u32 s46, s46, 6291456
    v_lshlrev_b32 v8, 6, v1
    buffer_load_dword v7, v8, s[32:35], s46 offen sc1
    s_add_u32 s46, s62, 221184
    buffer_load_dwordx4 v[40:43], v2, s[32:35], s46 offen offset:0 sc1
    buffer_load_dwordx4 v[44:47], v2, s[32:35], s46 offen offset:1024 sc1
    buffer_load_dwordx4 v[48:51], v2, s[32:35], s46 offen offset:2048 sc1
    s_add_u32 s46, s62, 224256
    buffer_load_dwordx4 v[52:55], v2, s[32:35], s46 offen offset:0 sc1
    buffer_load_dwordx4 v[56:59], v2, s[32:35], s46 offen offset:1024 sc1
    buffer_load_dwordx4 v[60:63], v2, s[32:35], s46 offen offset:2048 sc1
    s_add_u32 s46, s62, 258048
    buffer_load_dwordx4 v[64:67], v2, s[32:35], s46 offen offset:0 sc1
    buffer_load_dwordx4 v[68:71], v2, s[32:35], s46 offen offset:1024 sc1
    buffer_load_dwordx4 v[72:75], v2, s[32:35], s46 offen offset:2048 sc1
    s_add_u32 s46, s62, 261120
    buffer_load_dwordx4 v[76:79], v2, s[32:35], s46 offen offset:0 sc1
    buffer_load_dwordx4 v[80:83], v2, s[32:35], s46 offen offset:1024 sc1
    buffer_load_dwordx4 v[84:87], v2, s[32:35], s46 offen offset:2048 sc1
    s_add_u32 s46, s62, 294912
    buffer_load_dwordx4 v[88:91], v2, s[32:35], s46 offen offset:0 sc1
    buffer_load_dwordx4 v[92:95], v2, s[32:35], s46 offen offset:1024 sc1
    buffer_load_dwordx4 v[96:99], v2, s[32:35], s46 offen offset:2048 sc1
    s_add_u32 s46, s62, 297984
    buffer_load_dwordx4 v[100:103], v2, s[32:35], s46 offen offset:0 sc1
    buffer_load_dwordx4 v[104:107], v2, s[32:35], s46 offen offset:1024 sc1
    buffer_load_dwordx4 v[108:111], v2, s[32:35], s46 offen offset:2048 sc1
    s_waitcnt vmcnt(0)
    v_lshlrev_b32 v7, 6, v5
    v_add_u32 v7, 100352, v7
    s_mul_i32 s46, s40, 18
    s_add_u32 s46, s46, 0
    v_add_u32 v8, s46, v6
    v_lshrrev_b32 v9, 2, v8
    v_lshlrev_b32 v9, 12, v9
    v_lshl_add_u32 v9, v5, 4, v9
    v_and_b32 v8, 3, v8
    v_lshl_add_u32 v3, v8, 8, v9
    s_mul_i32 s52, s56, 73728
    s_lshr_b32 s47, s43, 1
    s_lshl_b32 s47, s47, 10
    s_add_u32 s52, s52, s47
    s_and_b32 s47, s43, 1
    s_lshl_b32 s47, s47, 7
    s_add_u32 s52, s52, s47
    s_add_u32 s52, s52, 3407872
    s_lshl_b32 s53, s3, 3
L_warm_from:
    s_barrier
    ds_read_b128 v[8:11], v4 offset:0
    ds_read_b128 v[12:15], v4 offset:64
    s_waitcnt lgkmcnt(1)
    v_mfma_f32_16x16x32_bf16 v[16:19], v[184:187], v[8:11], v[16:19]
    v_mfma_f32_16x16x32_bf16 v[20:23], v[188:191], v[8:11], v[20:23]
    v_mfma_f32_16x16x32_bf16 v[24:27], v[192:195], v[8:11], v[24:27]
    v_mfma_f32_16x16x32_bf16 v[28:31], v[196:199], v[8:11], v[28:31]
    v_mfma_f32_16x16x32_bf16 v[32:35], v[200:203], v[8:11], v[32:35]
    v_mfma_f32_16x16x32_bf16 v[36:39], v[204:207], v[8:11], v[36:39]
    ds_read_b128 v[8:11], v4 offset:128
    s_waitcnt lgkmcnt(1)
    v_mfma_f32_16x16x32_bf16 v[16:19], v[208:211], v[12:15], v[16:19]
    v_mfma_f32_16x16x32_bf16 v[20:23], v[212:215], v[12:15], v[20:23]
    v_mfma_f32_16x16x32_bf16 v[24:27], v[216:219], v[12:15], v[24:27]
    v_mfma_f32_16x16x32_bf16 v[28:31], v[220:223], v[12:15], v[28:31]
    v_mfma_f32_16x16x32_bf16 v[32:35], v[224:227], v[12:15], v[32:35]
    v_mfma_f32_16x16x32_bf16 v[36:39], v[228:231], v[12:15], v[36:39]
    ds_read_b128 v[12:15], v4 offset:192
    s_waitcnt lgkmcnt(1)
    v_mfma_f32_16x16x32_bf16 v[16:19], v[232:235], v[8:11], v[16:19]
    v_mfma_f32_16x16x32_bf16 v[20:23], v[236:239], v[8:11], v[20:23]
    v_mfma_f32_16x16x32_bf16 v[24:27], v[240:243], v[8:11], v[24:27]
    v_mfma_f32_16x16x32_bf16 v[28:31], v[244:247], v[8:11], v[28:31]
    v_mfma_f32_16x16x32_bf16 v[32:35], v[248:251], v[8:11], v[32:35]
    v_mfma_f32_16x16x32_bf16 v[36:39], v[252:255], v[8:11], v[36:39]
    ds_read_b128 v[8:11], v4 offset:256
    s_waitcnt lgkmcnt(1)
    v_mfma_f32_16x16x32_bf16 v[16:19], v[112:115], v[12:15], v[16:19]
    v_mfma_f32_16x16x32_bf16 v[20:23], v[116:119], v[12:15], v[20:23]
    v_mfma_f32_16x16x32_bf16 v[24:27], v[120:123], v[12:15], v[24:27]
    v_mfma_f32_16x16x32_bf16 v[28:31], v[124:127], v[12:15], v[28:31]
    v_mfma_f32_16x16x32_bf16 v[32:35], v[128:131], v[12:15], v[32:35]
    v_mfma_f32_16x16x32_bf16 v[36:39], v[132:135], v[12:15], v[36:39]
    ds_read_b128 v[12:15], v4 offset:320
    s_waitcnt lgkmcnt(1)
    v_mfma_f32_16x16x32_bf16 v[16:19], v[136:139], v[8:11], v[16:19]
    v_mfma_f32_16x16x32_bf16 v[20:23], v[140:143], v[8:11], v[20:23]
    v_mfma_f32_16x16x32_bf16 v[24:27], v[144:147], v[8:11], v[24:27]
    v_mfma_f32_16x16x32_bf16 v[28:31], v[148:151], v[8:11], v[28:31]
    v_mfma_f32_16x16x32_bf16 v[32:35], v[152:155], v[8:11], v[32:35]
    v_mfma_f32_16x16x32_bf16 v[36:39], v[156:159], v[8:11], v[36:39]
    ds_read_b128 v[8:11], v4 offset:384
    s_waitcnt lgkmcnt(1)
    v_mfma_f32_16x16x32_bf16 v[16:19], v[160:163], v[12:15], v[16:19]
    v_mfma_f32_16x16x32_bf16 v[20:23], v[164:167], v[12:15], v[20:23]
    v_mfma_f32_16x16x32_bf16 v[24:27], v[168:171], v[12:15], v[24:27]
    v_mfma_f32_16x16x32_bf16 v[28:31], v[172:175], v[12:15], v[28:31]
    v_mfma_f32_16x16x32_bf16 v[32:35], v[176:179], v[12:15], v[32:35]
    v_mfma_f32_16x16x32_bf16 v[36:39], v[180:183], v[12:15], v[36:39]
    ds_read_b128 v[12:15], v4 offset:448
    s_waitcnt lgkmcnt(1)
    v_mfma_f32_16x16x32_bf16 v[16:19], v[40:43], v[8:11], v[16:19]
    v_mfma_f32_16x16x32_bf16 v[20:23], v[44:47], v[8:11], v[20:23]
    v_mfma_f32_16x16x32_bf16 v[24:27], v[48:51], v[8:11], v[24:27]
    v_mfma_f32_16x16x32_bf16 v[28:31], v[52:55], v[8:11], v[28:31]
    v_mfma_f32_16x16x32_bf16 v[32:35], v[56:59], v[8:11], v[32:35]
    v_mfma_f32_16x16x32_bf16 v[36:39], v[60:63], v[8:11], v[36:39]
    ds_read_b128 v[8:11], v4 offset:512
    s_waitcnt lgkmcnt(1)
    v_mfma_f32_16x16x32_bf16 v[16:19], v[64:67], v[12:15], v[16:19]
    v_mfma_f32_16x16x32_bf16 v[20:23], v[68:71], v[12:15], v[20:23]
    v_mfma_f32_16x16x32_bf16 v[24:27], v[72:75], v[12:15], v[24:27]
    v_mfma_f32_16x16x32_bf16 v[28:31], v[76:79], v[12:15], v[28:31]
    v_mfma_f32_16x16x32_bf16 v[32:35], v[80:83], v[12:15], v[32:35]
    v_mfma_f32_16x16x32_bf16 v[36:39], v[84:87], v[12:15], v[36:39]
    s_waitcnt lgkmcnt(0)
    v_mfma_f32_16x16x32_bf16 v[16:19], v[88:91], v[8:11], v[16:19]
    v_mfma_f32_16x16x32_bf16 v[20:23], v[92:95], v[8:11], v[20:23]
    v_mfma_f32_16x16x32_bf16 v[24:27], v[96:99], v[8:11], v[24:27]
    v_mfma_f32_16x16x32_bf16 v[28:31], v[100:103], v[8:11], v[28:31]
    v_mfma_f32_16x16x32_bf16 v[32:35], v[104:107], v[8:11], v[32:35]
    v_mfma_f32_16x16x32_bf16 v[36:39], v[108:111], v[8:11], v[36:39]
    s_nop 2
    v_add_f32_dpp v16, v16, v16 row_ror:8 row_mask:0xf bank_mask:0xf
    v_add_f32_dpp v17, v17, v17 row_ror:8 row_mask:0xf bank_mask:0xf
    v_add_f32_dpp v18, v18, v18 row_ror:8 row_mask:0xf bank_mask:0xf
    v_add_f32_dpp v19, v19, v19 row_ror:8 row_mask:0xf bank_mask:0xf
    v_add_f32_dpp v20, v20, v20 row_ror:8 row_mask:0xf bank_mask:0xf
    v_add_f32_dpp v21, v21, v21 row_ror:8 row_mask:0xf bank_mask:0xf
    v_add_f32_dpp v22, v22, v22 row_ror:8 row_mask:0xf bank_mask:0xf
    v_add_f32_dpp v23, v23, v23 row_ror:8 row_mask:0xf bank_mask:0xf
    v_add_f32_dpp v24, v24, v24 row_ror:8 row_mask:0xf bank_mask:0xf
    v_add_f32_dpp v25, v25, v25 row_ror:8 row_mask:0xf bank_mask:0xf
    v_add_f32_dpp v26, v26, v26 row_ror:8 row_mask:0xf bank_mask:0xf
    v_add_f32_dpp v27, v27, v27 row_ror:8 row_mask:0xf bank_mask:0xf
    v_add_f32_dpp v28, v28, v28 row_ror:8 row_mask:0xf bank_mask:0xf
    v_add_f32_dpp v29, v29, v29 row_ror:8 row_mask:0xf bank_mask:0xf
    v_add_f32_dpp v30, v30, v30 row_ror:8 row_mask:0xf bank_mask:0xf
    v_add_f32_dpp v31, v31, v31 row_ror:8 row_mask:0xf bank_mask:0xf
    v_add_f32_dpp v32, v32, v32 row_ror:8 row_mask:0xf bank_mask:0xf
    v_add_f32_dpp v33, v33, v33 row_ror:8 row_mask:0xf bank_mask:0xf
    v_add_f32_dpp v34, v34, v34 row_ror:8 row_mask:0xf bank_mask:0xf
    v_add_f32_dpp v35, v35, v35 row_ror:8 row_mask:0xf bank_mask:0xf
    v_add_f32_dpp v36, v36, v36 row_ror:8 row_mask:0xf bank_mask:0xf
    v_add_f32_dpp v37, v37, v37 row_ror:8 row_mask:0xf bank_mask:0xf
    v_add_f32_dpp v38, v38, v38 row_ror:8 row_mask:0xf bank_mask:0xf
    v_add_f32_dpp v39, v39, v39 row_ror:8 row_mask:0xf bank_mask:0xf
    v_pk_add_f32 v[12:13], v[16:17], v[18:19]
    v_pk_mul_f32 v[14:15], v[16:17], v[16:17]
    v_pk_fma_f32 v[14:15], v[18:19], v[18:19], v[14:15]
    v_pk_add_f32 v[12:13], v[12:13], v[20:21]
    v_pk_fma_f32 v[14:15], v[20:21], v[20:21], v[14:15]
    v_pk_add_f32 v[12:13], v[12:13], v[22:23]
    v_pk_fma_f32 v[14:15], v[22:23], v[22:23], v[14:15]
    v_pk_add_f32 v[12:13], v[12:13], v[24:25]
    v_pk_fma_f32 v[14:15], v[24:25], v[24:25], v[14:15]
    v_pk_add_f32 v[12:13], v[12:13], v[26:27]
    v_pk_fma_f32 v[14:15], v[26:27], v[26:27], v[14:15]
    v_pk_add_f32 v[12:13], v[12:13], v[28:29]
    v_pk_fma_f32 v[14:15], v[28:29], v[28:29], v[14:15]
    v_pk_add_f32 v[12:13], v[12:13], v[30:31]
    v_pk_fma_f32 v[14:15], v[30:31], v[30:31], v[14:15]
    v_pk_add_f32 v[12:13], v[12:13], v[32:33]
    v_pk_fma_f32 v[14:15], v[32:33], v[32:33], v[14:15]
    v_pk_add_f32 v[12:13], v[12:13], v[34:35]
    v_pk_fma_f32 v[14:15], v[34:35], v[34:35], v[14:15]
    v_pk_add_f32 v[12:13], v[12:13], v[36:37]
    v_pk_fma_f32 v[14:15], v[36:37], v[36:37], v[14:15]
    v_pk_add_f32 v[12:13], v[12:13], v[38:39]
    v_pk_fma_f32 v[14:15], v[38:39], v[38:39], v[14:15]
    v_add_f32 v8, v12, v13
    v_add_f32 v9, v14, v15
    v_add_u32 v11, s53, v7
    s_nop 0
    v_permlane32_swap_b32 v8, v9
    v_add_f32 v8, v8, v9
    v_lshrrev_b32 v10, 5, v1
    v_mov_b32 v9, v8
    v_lshl_add_u32 v11, v10, 2, v11
    s_nop 0
    v_permlane16_swap_b32 v8, v9
    v_add_f32 v8, v8, v9
    s_mov_b32 s46, 0xff
    s_mov_b32 s47, 0xff
    s_mov_b64 exec, s[46:47]
    ds_write_b32 v11, v8
    s_mov_b64 exec, -1
    s_waitcnt lgkmcnt(0)
    s_barrier
    ds_read_b128 v[148:151], v7 offset:0
    ds_read_b128 v[152:155], v7 offset:16
    ds_read_b128 v[156:159], v7 offset:32
    ds_read_b128 v[160:163], v7 offset:48
    v_cvt_pk_bf16_f32 v136, v16, v17
    v_cvt_pk_bf16_f32 v137, v18, v19
    v_cvt_pk_bf16_f32 v138, v20, v21
    v_cvt_pk_bf16_f32 v139, v22, v23
    v_cvt_pk_bf16_f32 v140, v24, v25
    v_cvt_pk_bf16_f32 v141, v26, v27
    v_cvt_pk_bf16_f32 v142, v28, v29
    v_cvt_pk_bf16_f32 v143, v30, v31
    v_cvt_pk_bf16_f32 v144, v32, v33
    v_cvt_pk_bf16_f32 v145, v34, v35
    v_cvt_pk_bf16_f32 v146, v36, v37
    v_cvt_pk_bf16_f32 v147, v38, v39
    s_waitcnt lgkmcnt(0)
    v_pk_add_f32 v[148:149], v[148:149], v[156:157]
    v_pk_add_f32 v[150:151], v[150:151], v[158:159]
    v_pk_add_f32 v[152:153], v[152:153], v[160:161]
    v_pk_add_f32 v[154:155], v[154:155], v[162:163]
    v_pk_add_f32 v[148:149], v[148:149], v[152:153]
    v_pk_add_f32 v[150:151], v[150:151], v[154:155]
    v_pk_add_f32 v[148:149], v[148:149], v[150:151]
    v_mul_f32 v8, 0x3ae38e39, v148
    v_mul_f32 v9, 0x3ae38e39, v149
    v_fma_f32 v9, -v8, v8, v9
    v_max_f32 v9, 0, v9
    v_mov_b32 v10, 0x2ffa496c
    v_fmac_f32 v10, 0x4091b003, v9
    v_rsq_f32 v10, v10
    s_mov_b64 exec, s[54:55]
    v_mul_f32 v8, -v8, v10
    v_pk_fma_f32 v[16:17], v[16:17], v[10:11], v[8:9] op_sel_hi:[1,0,0]
    v_pk_fma_f32 v[18:19], v[18:19], v[10:11], v[8:9] op_sel_hi:[1,0,0]
    v_pk_fma_f32 v[20:21], v[20:21], v[10:11], v[8:9] op_sel_hi:[1,0,0]
    v_pk_fma_f32 v[22:23], v[22:23], v[10:11], v[8:9] op_sel_hi:[1,0,0]
    v_cvt_pk_bf16_f32 v164, v16, v17
    v_cvt_pk_bf16_f32 v165, v18, v19
    v_cvt_pk_bf16_f32 v166, v20, v21
    v_cvt_pk_bf16_f32 v167, v22, v23
    buffer_store_dwordx4 v[164:167], v3, s[32:35], s52 offen sc1
    s_add_u32 s52, s52, 4096
    v_pk_fma_f32 v[24:25], v[24:25], v[10:11], v[8:9] op_sel_hi:[1,0,0]
    v_pk_fma_f32 v[26:27], v[26:27], v[10:11], v[8:9] op_sel_hi:[1,0,0]
    v_pk_fma_f32 v[28:29], v[28:29], v[10:11], v[8:9] op_sel_hi:[1,0,0]
    v_pk_fma_f32 v[30:31], v[30:31], v[10:11], v[8:9] op_sel_hi:[1,0,0]
    v_cvt_pk_bf16_f32 v168, v24, v25
    v_cvt_pk_bf16_f32 v169, v26, v27
    v_cvt_pk_bf16_f32 v170, v28, v29
    v_cvt_pk_bf16_f32 v171, v30, v31
    buffer_store_dwordx4 v[168:171], v3, s[32:35], s52 offen sc1
    s_add_u32 s52, s52, 4096
    v_pk_fma_f32 v[32:33], v[32:33], v[10:11], v[8:9] op_sel_hi:[1,0,0]
    v_pk_fma_f32 v[34:35], v[34:35], v[10:11], v[8:9] op_sel_hi:[1,0,0]
    v_pk_fma_f32 v[36:37], v[36:37], v[10:11], v[8:9] op_sel_hi:[1,0,0]
    v_pk_fma_f32 v[38:39], v[38:39], v[10:11], v[8:9] op_sel_hi:[1,0,0]
    v_cvt_pk_bf16_f32 v172, v32, v33
    v_cvt_pk_bf16_f32 v173, v34, v35
    v_cvt_pk_bf16_f32 v174, v36, v37
    v_cvt_pk_bf16_f32 v175, v38, v39
    buffer_store_dwordx4 v[172:175], v3, s[32:35], s52 offen sc1
    s_mov_b64 exec, -1
    s_barrier
    s_mul_i32 s46, s40, 2304
    s_add_u32 s46, s46, 152064
    v_lshl_add_u32 v13, v5, 4, s46
    v_lshl_add_u32 v14, v6, 7, v13
    s_mov_b64 exec, s[54:55]
    ds_write_b128 v14, v[136:139] offset:0
    ds_write_b128 v14, v[140:143] offset:512
    ds_write_b128 v14, v[144:147] offset:1024
    s_mov_b64 exec, -1
    s_branch L_m_roleB
L_a_young_tail:
    s_setprio 3
    v_mov_b64 v[16:17], 0
    v_mov_b64 v[18:19], 0
    v_mov_b64 v[20:21], 0
    v_mov_b64 v[22:23], 0
    v_mov_b64 v[24:25], 0
    v_mov_b64 v[26:27], 0
    s_waitcnt vmcnt(0) lgkmcnt(0)
    s_barrier
    s_mov_b64 exec, s[54:55]
    ds_read_b128 v[16:19], v3 offset:0
    ds_read_b128 v[20:23], v3 offset:512
    ds_read_b128 v[24:27], v3 offset:1024
    s_mov_b64 exec, -1
    ds_read_b128 v[104:107], v4 offset:0
    ds_read_b128 v[108:111], v4 offset:64
    ds_read_b128 v[112:115], v4 offset:128
    ds_read_b128 v[116:119], v4 offset:192
    ds_read_b128 v[120:123], v4 offset:256
    ds_read_b128 v[124:127], v4 offset:320
    ds_read_b128 v[128:131], v4 offset:384
    ds_read_b128 v[132:135], v4 offset:448
    ds_read_b128 v[136:139], v4 offset:512
    v_lshlrev_b32 v143, 6, v5
    v_add_u32 v143, 100352, v143
    s_mul_i32 s46, s40, 18
    s_add_u32 s46, s46, 12
    v_add_u32 v8, s46, v6
    v_lshrrev_b32 v9, 2, v8
    v_lshlrev_b32 v9, 12, v9
    v_lshl_add_u32 v9, v5, 4, v9
    v_and_b32 v8, 3, v8
    v_lshl_add_u32 v142, v8, 8, v9
    v_lshrrev_b32 v8, 1, v6
    s_add_u32 s46, s46, 4
    v_add_u32 v8, s46, v8
    v_lshrrev_b32 v9, 2, v8
    v_lshlrev_b32 v9, 12, v9
    v_lshl_add_u32 v9, v5, 4, v9
    v_and_b32 v8, 3, v8
    v_lshl_add_u32 v9, v8, 8, v9
    v_and_b32 v8, 1, v6
    v_lshl_add_u32 v144, v8, 3, v9
    s_mul_i32 s52, s56, 73728
    s_lshr_b32 s47, s43, 1
    s_lshl_b32 s47, s47, 10
    s_add_u32 s52, s52, s47
    s_and_b32 s47, s43, 1
    s_lshl_b32 s47, s47, 7
    s_add_u32 s52, s52, s47
    s_add_u32 s52, s52, 3407872
    s_lshl_b32 s53, s3, 3
    s_waitcnt lgkmcnt(8)
    v_mfma_f32_16x16x32_bf16 v[16:19], v[148:151], v[104:107], v[16:19]
    buffer_load_dwordx4 v[28:31], v2, s[64:67], s70 offen offset:0 sc1
    v_mfma_f32_16x16x32_bf16 v[20:23], v[152:155], v[104:107], v[20:23]
    v_mfma_f32_16x16x32_bf16 v[24:27], v[156:159], v[104:107], v[24:27]
    buffer_load_dwordx4 v[32:35], v2, s[64:67], s70 offen offset:1024 sc1
    s_waitcnt lgkmcnt(7)
    v_mfma_f32_16x16x32_bf16 v[16:19], v[160:163], v[108:111], v[16:19]
    buffer_load_dwordx4 v[36:39], v2, s[64:67], s70 offen offset:2048 sc1
    s_add_u32 s70, s70, 3072
    v_mfma_f32_16x16x32_bf16 v[20:23], v[164:167], v[108:111], v[20:23]
    v_mfma_f32_16x16x32_bf16 v[24:27], v[168:171], v[108:111], v[24:27]
    buffer_load_dwordx4 v[40:43], v2, s[64:67], s70 offen offset:0 sc1
    s_waitcnt lgkmcnt(6)
    v_mfma_f32_16x16x32_bf16 v[16:19], v[172:175], v[112:115], v[16:19]
    buffer_load_dwordx4 v[44:47], v2, s[64:67], s70 offen offset:1024 sc1
    v_mfma_f32_16x16x32_bf16 v[20:23], v[176:179], v[112:115], v[20:23]
    v_mfma_f32_16x16x32_bf16 v[24:27], v[180:183], v[112:115], v[24:27]
    buffer_load_dwordx4 v[48:51], v2, s[64:67], s70 offen offset:2048 sc1
    s_add_u32 s70, s70, 3072
    s_waitcnt lgkmcnt(5)
    v_mfma_f32_16x16x32_bf16 v[16:19], v[184:187], v[116:119], v[16:19]
    buffer_load_dwordx4 v[52:55], v2, s[64:67], s70 offen offset:0 sc1
    v_mfma_f32_16x16x32_bf16 v[20:23], v[188:191], v[116:119], v[20:23]
    v_mfma_f32_16x16x32_bf16 v[24:27], v[192:195], v[116:119], v[24:27]
    buffer_load_dwordx4 v[56:59], v2, s[64:67], s70 offen offset:1024 sc1
    s_waitcnt lgkmcnt(4)
    v_mfma_f32_16x16x32_bf16 v[16:19], v[196:199], v[120:123], v[16:19]
    buffer_load_dwordx4 v[60:63], v2, s[64:67], s70 offen offset:2048 sc1
    s_add_u32 s70, s70, 3072
    v_mfma_f32_16x16x32_bf16 v[20:23], v[200:203], v[120:123], v[20:23]
    v_mfma_f32_16x16x32_bf16 v[24:27], v[204:207], v[120:123], v[24:27]
    buffer_load_dwordx4 v[64:67], v2, s[64:67], s70 offen offset:0 sc1
    s_waitcnt lgkmcnt(3)
    v_mfma_f32_16x16x32_bf16 v[16:19], v[208:211], v[124:127], v[16:19]
    buffer_load_dwordx4 v[68:71], v2, s[64:67], s70 offen offset:1024 sc1
    v_mfma_f32_16x16x32_bf16 v[20:23], v[212:215], v[124:127], v[20:23]
    v_mfma_f32_16x16x32_bf16 v[24:27], v[216:219], v[124:127], v[24:27]
    buffer_load_dwordx4 v[72:75], v2, s[64:67], s70 offen offset:2048 sc1
    s_add_u32 s70, s70, 3072
    s_waitcnt lgkmcnt(2)
    v_mfma_f32_16x16x32_bf16 v[16:19], v[220:223], v[128:131], v[16:19]
    buffer_load_dwordx4 v[76:79], v2, s[64:67], s70 offen offset:0 sc1
    v_mfma_f32_16x16x32_bf16 v[20:23], v[224:227], v[128:131], v[20:23]
    v_mfma_f32_16x16x32_bf16 v[24:27], v[228:231], v[128:131], v[24:27]
    buffer_load_dwordx4 v[80:83], v2, s[64:67], s70 offen offset:1024 sc1
    s_waitcnt lgkmcnt(1)
    v_mfma_f32_16x16x32_bf16 v[16:19], v[232:235], v[132:135], v[16:19]
    buffer_load_dwordx4 v[84:87], v2, s[64:67], s70 offen offset:2048 sc1
    s_add_u32 s70, s70, 3072
    v_mfma_f32_16x16x32_bf16 v[20:23], v[236:239], v[132:135], v[20:23]
    v_mfma_f32_16x16x32_bf16 v[24:27], v[240:243], v[132:135], v[24:27]
    buffer_load_dwordx4 v[88:91], v2, s[64:67], s70 offen offset:0 sc1
    s_waitcnt lgkmcnt(0)
    v_mfma_f32_16x16x32_bf16 v[16:19], v[244:247], v[136:139], v[16:19]
    buffer_load_dwordx4 v[92:95], v2, s[64:67], s70 offen offset:1024 sc1
    v_mfma_f32_16x16x32_bf16 v[20:23], v[248:251], v[136:139], v[20:23]
    v_mfma_f32_16x16x32_bf16 v[24:27], v[252:255], v[136:139], v[24:27]
    buffer_load_dwordx4 v[96:99], v2, s[64:67], s70 offen offset:2048 sc1
    s_add_u32 s70, s70, 3072
    s_nop 2
    v_add_f32_dpp v16, v16, v16 row_ror:8 row_mask:0xf bank_mask:0xf
    v_add_f32_dpp v17, v17, v17 row_ror:8 row_mask:0xf bank_mask:0xf
    v_add_f32_dpp v18, v18, v18 row_ror:8 row_mask:0xf bank_mask:0xf
    v_add_f32_dpp v19, v19, v19 row_ror:8 row_mask:0xf bank_mask:0xf
    v_add_f32_dpp v20, v20, v20 row_ror:8 row_mask:0xf bank_mask:0xf
    v_add_f32_dpp v21, v21, v21 row_ror:8 row_mask:0xf bank_mask:0xf
    v_add_f32_dpp v22, v22, v22 row_ror:8 row_mask:0xf bank_mask:0xf
    v_add_f32_dpp v23, v23, v23 row_ror:8 row_mask:0xf bank_mask:0xf
    v_add_f32_dpp v24, v24, v24 row_ror:8 row_mask:0xf bank_mask:0xf
    v_add_f32_dpp v25, v25, v25 row_ror:8 row_mask:0xf bank_mask:0xf
    v_add_f32_dpp v26, v26, v26 row_ror:8 row_mask:0xf bank_mask:0xf
    v_add_f32_dpp v27, v27, v27 row_ror:8 row_mask:0xf bank_mask:0xf
    v_add_f32 v8, v16, v17
    v_mul_f32 v9, v16, v16
    v_fmac_f32 v9, v17, v17
    v_add_f32 v8, v8, v18
    v_fmac_f32 v9, v18, v18
    v_add_f32 v8, v8, v19
    v_fmac_f32 v9, v19, v19
    v_add_f32 v8, v8, v20
    v_fmac_f32 v9, v20, v20
    v_add_f32 v8, v8, v21
    v_fmac_f32 v9, v21, v21
    v_add_f32 v8, v8, v22
    v_fmac_f32 v9, v22, v22
    v_add_f32 v8, v8, v23
    v_fmac_f32 v9, v23, v23
    v_add_f32 v8, v8, v24
    v_fmac_f32 v9, v24, v24
    v_add_f32 v8, v8, v25
    v_fmac_f32 v9, v25, v25
    v_add_f32 v8, v8, v26
    v_fmac_f32 v9, v26, v26
    v_add_f32 v8, v8, v27
    v_fmac_f32 v9, v27, v27
    v_add_u32 v11, s53, v143
    s_nop 0
    v_permlane32_swap_b32 v8, v9
    v_add_f32 v8, v8, v9
    v_lshrrev_b32 v10, 5, v1
    v_mov_b32 v9, v8
    v_lshl_add_u32 v11, v10, 2, v11
    s_nop 0
    v_permlane16_swap_b32 v8, v9
    v_add_f32 v8, v8, v9
    s_mov_b32 s46, 0xff
    s_mov_b32 s47, 0xff
    s_mov_b64 exec, s[46:47]
    ds_write_b32 v11, v8
    s_mov_b64 exec, -1
    s_waitcnt lgkmcnt(0)
    s_barrier
    ds_read_b128 v[160:163], v143 offset:0
    ds_read_b128 v[164:167], v143 offset:16
    ds_read_b128 v[168:171], v143 offset:32
    ds_read_b128 v[172:175], v143 offset:48
    v_cvt_pk_bf16_f32 v148, v16, v17
    v_cvt_pk_bf16_f32 v149, v18, v19
    v_cvt_pk_bf16_f32 v150, v20, v21
    v_cvt_pk_bf16_f32 v151, v22, v23
    v_cvt_pk_bf16_f32 v152, v24, v25
    v_cvt_pk_bf16_f32 v153, v26, v27
    s_waitcnt lgkmcnt(0)
    v_pk_add_f32 v[160:161], v[160:161], v[168:169]
    v_pk_add_f32 v[162:163], v[162:163], v[170:171]
    v_pk_add_f32 v[164:165], v[164:165], v[172:173]
    v_pk_add_f32 v[166:167], v[166:167], v[174:175]
    v_pk_add_f32 v[160:161], v[160:161], v[164:165]
    v_pk_add_f32 v[162:163], v[162:163], v[166:167]
    v_pk_add_f32 v[160:161], v[160:161], v[162:163]
    v_mul_f32 v8, 0x3ae38e39, v160
    v_mul_f32 v9, 0x3ae38e39, v161
    v_fma_f32 v9, -v8, v8, v9
    v_max_f32 v9, 0, v9
    v_mov_b32 v10, 0x2ffa496c
    v_fmac_f32 v10, 0x4091b003, v9
    v_rsq_f32 v10, v10
    s_mov_b64 exec, s[54:55]
    v_mul_f32 v8, -v8, v10
    v_pk_fma_f32 v[16:17], v[16:17], v[10:11], v[8:9] op_sel_hi:[1,0,0]
    v_pk_fma_f32 v[18:19], v[18:19], v[10:11], v[8:9] op_sel_hi:[1,0,0]
    v_pk_fma_f32 v[20:21], v[20:21], v[10:11], v[8:9] op_sel_hi:[1,0,0]
    v_pk_fma_f32 v[22:23], v[22:23], v[10:11], v[8:9] op_sel_hi:[1,0,0]
    v_cvt_pk_bf16_f32 v176, v16, v17
    v_cvt_pk_bf16_f32 v177, v18, v19
    v_cvt_pk_bf16_f32 v178, v20, v21
    v_cvt_pk_bf16_f32 v179, v22, v23
    buffer_store_dwordx4 v[176:179], v142, s[32:35], s52 offen sc1
    v_pk_fma_f32 v[24:25], v[24:25], v[10:11], v[8:9] op_sel_hi:[1,0,0]
    v_pk_fma_f32 v[26:27], v[26:27], v[10:11], v[8:9] op_sel_hi:[1,0,0]
    v_cvt_pk_bf16_f32 v180, v24, v25
    v_cvt_pk_bf16_f32 v181, v26, v27
    buffer_store_dwordx2 v[180:181], v144, s[32:35], s52 offen sc1
    s_mov_b64 exec, -1
    s_barrier
    s_mul_i32 s46, s40, 2304
    s_add_u32 s46, s46, 153600
    v_lshl_add_u32 v13, v5, 4, s46
    v_lshl_add_u32 v14, v6, 7, v13
    v_lshrrev_b32 v15, 1, v6
    v_lshl_add_u32 v13, v15, 7, v13
    v_and_b32 v15, 1, v6
    v_lshl_add_u32 v13, v15, 3, v13
    s_mov_b64 exec, s[54:55]
    ds_write_b128 v14, v[148:151] offset:0
    ds_write_b64 v13, v[152:153] offset:512
    s_mov_b64 exec, -1
    buffer_load_dwordx4 v[100:103], v2, s[64:67], s70 offen offset:0 sc1
    buffer_load_dwordx4 v[104:107], v2, s[64:67], s70 offen offset:1024 sc1
    buffer_load_dwordx4 v[108:111], v2, s[64:67], s70 offen offset:2048 sc1
    s_add_u32 s70, s70, 3072
    s_lshl_b32 s46, s40, 6
    v_add_u32 v8, s46, v1
    v_lshlrev_b32 v11, 3, v8
    v_add_u32 v11, 147456, v11
    v_lshlrev_b32 v234, 16, v140
    v_and_b32 v235, 0xffff0000, v140
    v_lshlrev_b32 v236, 16, v141
    v_and_b32 v237, 0xffff0000, v141
    v_mul_f32 v234, 0x3eeff558, v234
    v_mul_f32 v235, 0x3eeff558, v235
    v_mul_f32 v236, 0x3eeff558, v236
    v_mul_f32 v237, 0x3eeff558, v237
    ds_write_b64 v11, v[234:235]
    v_lshrrev_b32 v12, 2, v8
    v_lshlrev_b32 v12, 5, v12
    v_and_b32 v13, 3, v8
    v_lshl_add_u32 v12, v13, 2, v12
    v_add_u32 v12, 149760, v12
    ds_write2_b32 v12, v234, v235 offset0:0 offset1:4
    v_add_u32 v12, 2048, v12
    s_cmp_lg_u32 s40, 0
    s_cbranch_scc1 L_m_roleA
    s_mov_b64 exec, s[50:51]
    ds_write_b64 v11, v[236:237] offset:2048
    ds_write2_b32 v12, v236, v237 offset0:0 offset1:4
    s_mov_b64 exec, -1
    s_branch L_m_roleA
L_a_inter:
    s_cmp_lg_u32 s41, 0
    s_cbranch_scc1 L_a_inter_y
    s_mov_b32 s49, 16384
L_a_kv2:
    ds_read_b32 v21, v20
    s_waitcnt lgkmcnt(0)
    v_readfirstlane_b32 s47, v21
    s_sub_u32 s49, s49, 1
    s_cbranch_scc1 L_a_kv2_ok
    s_cmp_ge_u32 s47, 4
    s_cbranch_scc1 L_a_kv2_ok
    s_sleep 2
    s_branch L_a_kv2
L_a_kv2_ok:
    s_branch L_a_loop
L_a_mid:
    v_mov_b32 v20, 163412
    s_mov_b32 s49, 16384
L_a_kv1:
    ds_read_b32 v21, v20
    s_waitcnt lgkmcnt(0)
    v_readfirstlane_b32 s47, v21
    s_sub_u32 s49, s49, 1
    s_cbranch_scc1 L_a_kv1_ok
    s_cmp_ge_u32 s47, 4
    s_cbranch_scc1 L_a_kv1_ok
    s_sleep 2
    s_branch L_a_kv1
L_a_kv1_ok:
    v_mov_b32 v20, 163408
    s_mov_b64 vcc, 0
    s_branch L_a_mid_back
L_a_inter_y:
    v_mov_b32 v5, 163328
    s_mov_b32 s49, 16384
L_a_poll2:
    ds_read_b32 v6, v5
    s_waitcnt lgkmcnt(0)
    v_readfirstlane_b32 s47, v6
    s_sub_u32 s49, s49, 1
    s_cbranch_scc1 L_a_poll2_ok
    s_cmp_ge_u32 s47, 8
    s_cbranch_scc1 L_a_poll2_ok
    s_sleep 2
    s_branch L_a_poll2
L_a_poll2_ok:
    s_branch L_a_loop
L_a_young_pre:
    s_lshl_b32 s58, s56, 2
    s_add_u32 s58, s58, s40
    s_min_u32 s59, s58, 119
    s_mov_b32 s76, 858993460
    s_mul_hi_u32 s72, s59, s76
    s_mul_i32 s76, s72, 5
    s_sub_u32 s73, s59, s76
    s_mov_b32 s76, 1431655766
    s_mul_hi_u32 s74, s72, s76
    s_mul_i32 s76, s74, 3
    s_sub_u32 s75, s72, s76
    s_lshl_b32 s73, s73, 2
    s_min_u32 s73, s73, 14
    s_lshr_b32 s76, s74, 2
    s_mul_i32 s76, s76, 3
    s_add_u32 s76, s76, s75
    s_lshl_b32 s76, s76, 2
    s_lshr_b32 s76, 5375553, s76
    s_bfe_u32 s77, s76, 0x10002
    s_and_b32 s78, s76, 3
    s_and_b32 s74, s74, 3
    s_mul_i32 s63, s72, 54
    s_mul_i32 s76, s73, 3
    s_add_u32 s63, s63, s76
    s_lshl_b32 s63, s63, 10
    s_mul_i32 s76, s43, 1327104
    s_add_u32 s63, s63, s76
    s_add_u32 s63, s63, 6291456
    s_cmp_eq_u32 s77, 0
    s_cselect_b32 s24, s16, s20
    s_cselect_b32 s25, s17, s21
    s_mov_b32 s62, 1152
    s_cmov_b32 s62, 9216
    s_mov_b32 s76, 663552
    s_cmov_b32 s76, 1152
    s_and_b32 s25, s25, 0xffff
    s_mov_b32 s26, 5308416
    s_mov_b32 s27, 0x00020000
    s_mul_i32 s61, s76, s43
    s_mul_i32 s76, s78, 384
    s_add_u32 s61, s61, s76
    s_lshl_b32 s76, s73, 5
    s_mul_i32 s76, s76, s62
    s_add_u32 s61, s61, s76
    v_and_b32 v7, 15, v1
    s_lshl_b32 s74, s74, 4
    v_add_u32 v7, s74, v7
    v_lshlrev_b32 v5, 2, v7
    v_lshlrev_b32 v6, 1, v7
    v_lshrrev_b32 v7, 4, v1
    s_lshl_b32 s76, s62, 3
    v_mad_u32_u24 v5, v7, s76, v5
    v_mad_u32_u24 v6, v7, s76, v6
    s_mul_i32 s79, s62, 24
    s_mov_b32 s72, 0x05040100
    s_mov_b32 s73, 0x07060302
    s_mov_b32 s59, 3
    s_waitcnt vmcnt(0)
    v_mov_b32 v20, 163408
    v_mov_b32 v21, 1
    s_mov_b64 exec, 1
    ds_add_u32 v20, v21
    s_mov_b64 exec, -1
    buffer_load_dword v144, v5, s[24:27], s61 offen
    buffer_load_ushort v152, v6, s[24:27], s61 offen offset:256
    s_add_u32 s61, s61, s62
    buffer_load_dword v145, v5, s[24:27], s61 offen
    buffer_load_ushort v153, v6, s[24:27], s61 offen offset:256
    s_add_u32 s61, s61, s62
    buffer_load_dword v146, v5, s[24:27], s61 offen
    buffer_load_ushort v154, v6, s[24:27], s61 offen offset:256
    s_add_u32 s61, s61, s62
    buffer_load_dword v147, v5, s[24:27], s61 offen
    buffer_load_ushort v155, v6, s[24:27], s61 offen offset:256
    s_add_u32 s61, s61, s62
    buffer_load_dword v148, v5, s[24:27], s61 offen
    buffer_load_ushort v156, v6, s[24:27], s61 offen offset:256
    s_add_u32 s61, s61, s62
    buffer_load_dword v149, v5, s[24:27], s61 offen
    buffer_load_ushort v157, v6, s[24:27], s61 offen offset:256
    s_add_u32 s61, s61, s62
    buffer_load_dword v150, v5, s[24:27], s61 offen
    buffer_load_ushort v158, v6, s[24:27], s61 offen offset:256
    s_add_u32 s61, s61, s62
    buffer_load_dword v151, v5, s[24:27], s61 offen
    buffer_load_ushort v159, v6, s[24:27], s61 offen offset:256
    s_add_u32 s61, s61, s62
    s_add_u32 s61, s61, s79
    buffer_load_dword v160, v5, s[24:27], s61 offen
    buffer_load_ushort v168, v6, s[24:27], s61 offen offset:256
    s_add_u32 s61, s61, s62
    buffer_load_dword v161, v5, s[24:27], s61 offen
    buffer_load_ushort v169, v6, s[24:27], s61 offen offset:256
    s_add_u32 s61, s61, s62
    buffer_load_dword v162, v5, s[24:27], s61 offen
    buffer_load_ushort v170, v6, s[24:27], s61 offen offset:256
    s_add_u32 s61, s61, s62
    buffer_load_dword v163, v5, s[24:27], s61 offen
    buffer_load_ushort v171, v6, s[24:27], s61 offen offset:256
    s_add_u32 s61, s61, s62
    buffer_load_dword v164, v5, s[24:27], s61 offen
    buffer_load_ushort v172, v6, s[24:27], s61 offen offset:256
    s_add_u32 s61, s61, s62
    buffer_load_dword v165, v5, s[24:27], s61 offen
    buffer_load_ushort v173, v6, s[24:27], s61 offen offset:256
    s_add_u32 s61, s61, s62
    buffer_load_dword v166, v5, s[24:27], s61 offen
    buffer_load_ushort v174, v6, s[24:27], s61 offen offset:256
    s_add_u32 s61, s61, s62
    buffer_load_dword v167, v5, s[24:27], s61 offen
    buffer_load_ushort v175, v6, s[24:27], s61 offen offset:256
    s_add_u32 s61, s61, s62
    s_add_u32 s61, s61, s79
    buffer_load_dword v176, v5, s[24:27], s61 offen
    buffer_load_ushort v184, v6, s[24:27], s61 offen offset:256
    s_add_u32 s61, s61, s62
    buffer_load_dword v177, v5, s[24:27], s61 offen
    buffer_load_ushort v185, v6, s[24:27], s61 offen offset:256
    s_add_u32 s61, s61, s62
    buffer_load_dword v178, v5, s[24:27], s61 offen
    buffer_load_ushort v186, v6, s[24:27], s61 offen offset:256
    s_add_u32 s61, s61, s62
    buffer_load_dword v179, v5, s[24:27], s61 offen
    buffer_load_ushort v187, v6, s[24:27], s61 offen offset:256
    s_add_u32 s61, s61, s62
    buffer_load_dword v180, v5, s[24:27], s61 offen
    buffer_load_ushort v188, v6, s[24:27], s61 offen offset:256
    s_add_u32 s61, s61, s62
    buffer_load_dword v181, v5, s[24:27], s61 offen
    buffer_load_ushort v189, v6, s[24:27], s61 offen offset:256
    s_add_u32 s61, s61, s62
    buffer_load_dword v182, v5, s[24:27], s61 offen
    buffer_load_ushort v190, v6, s[24:27], s61 offen offset:256
    s_add_u32 s61, s61, s62
    buffer_load_dword v183, v5, s[24:27], s61 offen
    buffer_load_ushort v191, v6, s[24:27], s61 offen offset:256
    s_add_u32 s61, s61, s62
    s_add_u32 s61, s61, s79
    s_waitcnt vmcnt(44)
    buffer_load_dword v192, v5, s[24:27], s61 offen
    buffer_load_ushort v200, v6, s[24:27], s61 offen offset:256
    s_add_u32 s61, s61, s62
    buffer_load_dword v193, v5, s[24:27], s61 offen
    buffer_load_ushort v201, v6, s[24:27], s61 offen offset:256
    s_add_u32 s61, s61, s62
    buffer_load_dword v194, v5, s[24:27], s61 offen
    buffer_load_ushort v202, v6, s[24:27], s61 offen offset:256
    s_add_u32 s61, s61, s62
    buffer_load_dword v195, v5, s[24:27], s61 offen
    buffer_load_ushort v203, v6, s[24:27], s61 offen offset:256
    s_add_u32 s61, s61, s62
    buffer_load_dword v196, v5, s[24:27], s61 offen
    buffer_load_ushort v204, v6, s[24:27], s61 offen offset:256
    s_add_u32 s61, s61, s62
    buffer_load_dword v197, v5, s[24:27], s61 offen
    buffer_load_ushort v205, v6, s[24:27], s61 offen offset:256
    s_add_u32 s61, s61, s62
    buffer_load_dword v198, v5, s[24:27], s61 offen
    buffer_load_ushort v206, v6, s[24:27], s61 offen offset:256
    s_add_u32 s61, s61, s62
    buffer_load_dword v199, v5, s[24:27], s61 offen
    buffer_load_ushort v207, v6, s[24:27], s61 offen offset:256
    s_add_u32 s61, s61, s62
    s_add_u32 s61, s61, s79
    s_mov_b32 s49, 16384
L_a_kvy:
    ds_read_b32 v21, v20
    s_waitcnt lgkmcnt(0)
    v_readfirstlane_b32 s47, v21
    s_sub_u32 s49, s49, 1
    s_cbranch_scc1 L_a_kvy_ok
    s_cmp_ge_u32 s47, 4
    s_cbranch_scc1 L_a_kvy_ok
    s_sleep 2
    s_branch L_a_kvy
L_a_kvy_ok:
L_peel:
    ds_read_b128 v[108:111], v2 offset:0
    s_mov_b64 exec, s[50:51]
    ds_read_b128 v[116:119], v2 offset:4096
    s_mov_b64 exec, -1
    ds_read_b128 v[112:115], v2 offset:1024
    s_mov_b64 exec, s[8:9]
    ds_read_b128 v[124:127], v4 offset:0
    ds_read_b128 v[128:131], v4 offset:576
    s_mov_b64 exec, -1
    s_waitcnt lgkmcnt(3)
    v_mfma_f32_32x32x8_bf16 v[36:51], v[116:117], v[12:13], 0
    s_nop 9
    v_mfma_f32_32x32x16_bf16 v[36:51], v[108:111], v[28:31], v[36:51]
    s_nop 10
    s_waitcnt lgkmcnt(0)
    v_mfma_f32_32x32x8_bf16 v[52:67], v[116:117], v[16:17], 0
    v_exp_f32 v36, v36
    v_exp_f32 v37, v37
    v_exp_f32 v38, v38
    v_exp_f32 v39, v39
    v_mfma_f32_32x32x16_bf16 v[92:107], v[136:139], v[72:75], v[92:107]
    s_mov_b64 exec, s[8:9]
    ds_read_b128 v[132:135], v4 offset:1152
    ds_read_b128 v[136:139], v4 offset:1728
    s_mov_b64 exec, -1
    v_cvt_pk_bf16_f32 v68, v36, v37
    v_cvt_pk_bf16_f32 v69, v38, v39
    v_exp_f32 v40, v40
    v_exp_f32 v41, v41
    v_exp_f32 v42, v42
    v_exp_f32 v43, v43
    v_mfma_f32_32x32x16_bf16 v[52:67], v[108:111], v[32:35], v[52:67]
    ds_read_b128 v[108:111], v2 offset:2048
    v_cvt_pk_bf16_f32 v70, v40, v41
    v_cvt_pk_bf16_f32 v71, v42, v43
    v_exp_f32 v44, v44
    v_exp_f32 v45, v45
    v_exp_f32 v46, v46
    v_exp_f32 v47, v47
    v_mfma_f32_32x32x16_bf16 v[76:91], v[124:127], v[68:71], v[76:91]
    v_cvt_pk_bf16_f32 v72, v44, v45
    v_cvt_pk_bf16_f32 v73, v46, v47
    v_exp_f32 v48, v48
    v_exp_f32 v49, v49
    v_exp_f32 v50, v50
    v_exp_f32 v51, v51
    v_cvt_pk_bf16_f32 v74, v48, v49
    v_cvt_pk_bf16_f32 v75, v50, v51
    v_mfma_f32_32x32x8_bf16 v[36:51], v[116:117], v[14:15], 0
    v_exp_f32 v52, v52
    v_exp_f32 v53, v53
    v_exp_f32 v54, v54
    v_exp_f32 v55, v55
    v_mfma_f32_32x32x16_bf16 v[76:91], v[128:131], v[72:75], v[76:91]
    v_cvt_pk_bf16_f32 v68, v52, v53
    v_cvt_pk_bf16_f32 v69, v54, v55
    v_exp_f32 v56, v56
    v_exp_f32 v57, v57
    v_exp_f32 v58, v58
    v_exp_f32 v59, v59
    v_mfma_f32_32x32x16_bf16 v[36:51], v[112:115], v[28:31], v[36:51]
    v_cvt_pk_bf16_f32 v70, v56, v57
    v_cvt_pk_bf16_f32 v71, v58, v59
    v_exp_f32 v60, v60
    v_exp_f32 v61, v61
    v_exp_f32 v62, v62
    v_exp_f32 v63, v63
    v_mfma_f32_32x32x16_bf16 v[92:107], v[124:127], v[68:71], v[92:107]
    v_cvt_pk_bf16_f32 v72, v60, v61
    v_cvt_pk_bf16_f32 v73, v62, v63
    v_exp_f32 v64, v64
    v_exp_f32 v65, v65
    v_exp_f32 v66, v66
    v_exp_f32 v67, v67
    v_cvt_pk_bf16_f32 v74, v64, v65
    v_cvt_pk_bf16_f32 v75, v66, v67
    s_waitcnt lgkmcnt(0)
    v_mfma_f32_32x32x8_bf16 v[52:67], v[116:117], v[18:19], 0
    s_mov_b64 exec, s[50:51]
    ds_read_b128 v[120:123], v2 offset:22528
    s_mov_b64 exec, -1
    v_exp_f32 v36, v36
    v_exp_f32 v37, v37
    v_exp_f32 v38, v38
    v_exp_f32 v39, v39
    v_mfma_f32_32x32x16_bf16 v[92:107], v[128:131], v[72:75], v[92:107]
    s_mov_b64 exec, s[8:9]
    ds_read_b128 v[124:127], v4 offset:2304
    ds_read_b128 v[128:131], v4 offset:2880
    s_mov_b64 exec, -1
    v_cvt_pk_bf16_f32 v68, v36, v37
    v_cvt_pk_bf16_f32 v69, v38, v39
    v_exp_f32 v40, v40
    v_exp_f32 v41, v41
    v_exp_f32 v42, v42
    v_exp_f32 v43, v43
    v_mfma_f32_32x32x16_bf16 v[52:67], v[112:115], v[32:35], v[52:67]
    ds_read_b128 v[112:115], v2 offset:3072
    v_cvt_pk_bf16_f32 v70, v40, v41
    v_cvt_pk_bf16_f32 v71, v42, v43
    v_exp_f32 v44, v44
    v_exp_f32 v45, v45
    v_exp_f32 v46, v46
    v_exp_f32 v47, v47
    v_mfma_f32_32x32x16_bf16 v[76:91], v[132:135], v[68:71], v[76:91]
    v_cvt_pk_bf16_f32 v72, v44, v45
    v_cvt_pk_bf16_f32 v73, v46, v47
    v_exp_f32 v48, v48
    v_exp_f32 v49, v49
    v_exp_f32 v50, v50
    v_exp_f32 v51, v51
    v_cvt_pk_bf16_f32 v74, v48, v49
    v_cvt_pk_bf16_f32 v75, v50, v51
    v_mfma_f32_32x32x8_bf16 v[36:51], v[118:119], v[12:13], 0
    v_exp_f32 v52, v52
    v_exp_f32 v53, v53
    v_exp_f32 v54, v54
    v_exp_f32 v55, v55
    v_mfma_f32_32x32x16_bf16 v[76:91], v[136:139], v[72:75], v[76:91]
    v_cvt_pk_bf16_f32 v68, v52, v53
    v_cvt_pk_bf16_f32 v69, v54, v55
    v_exp_f32 v56, v56
    v_exp_f32 v57, v57
    v_exp_f32 v58, v58
    v_exp_f32 v59, v59
    v_mfma_f32_32x32x16_bf16 v[36:51], v[108:111], v[28:31], v[36:51]
    v_cvt_pk_bf16_f32 v70, v56, v57
    v_cvt_pk_bf16_f32 v71, v58, v59
    v_exp_f32 v60, v60
    v_exp_f32 v61, v61
    v_exp_f32 v62, v62
    v_exp_f32 v63, v63
    v_mfma_f32_32x32x16_bf16 v[92:107], v[132:135], v[68:71], v[92:107]
    v_cvt_pk_bf16_f32 v72, v60, v61
    v_cvt_pk_bf16_f32 v73, v62, v63
    v_exp_f32 v64, v64
    v_exp_f32 v65, v65
    v_exp_f32 v66, v66
    v_exp_f32 v67, v67
    v_cvt_pk_bf16_f32 v74, v64, v65
    v_cvt_pk_bf16_f32 v75, v66, v67
    s_waitcnt lgkmcnt(0)
    v_mfma_f32_32x32x8_bf16 v[52:67], v[118:119], v[16:17], 0
    v_exp_f32 v36, v36
    v_exp_f32 v37, v37
    v_exp_f32 v38, v38
    v_exp_f32 v39, v39
    v_mfma_f32_32x32x16_bf16 v[92:107], v[136:139], v[72:75], v[92:107]
    s_mov_b64 exec, s[8:9]
    ds_read_b128 v[132:135], v4 offset:3456
    ds_read_b128 v[136:139], v4 offset:4032
    s_mov_b64 exec, -1
    v_cvt_pk_bf16_f32 v68, v36, v37
    v_cvt_pk_bf16_f32 v69, v38, v39
    v_exp_f32 v40, v40
    v_exp_f32 v41, v41
    v_exp_f32 v42, v42
    v_exp_f32 v43, v43
    v_mfma_f32_32x32x16_bf16 v[52:67], v[108:111], v[32:35], v[52:67]
    ds_read_b128 v[108:111], v2 offset:18432
    v_cvt_pk_bf16_f32 v70, v40, v41
    v_cvt_pk_bf16_f32 v71, v42, v43
    v_exp_f32 v44, v44
    v_exp_f32 v45, v45
    v_exp_f32 v46, v46
    v_exp_f32 v47, v47
    v_mfma_f32_32x32x16_bf16 v[76:91], v[124:127], v[68:71], v[76:91]
    v_cvt_pk_bf16_f32 v72, v44, v45
    v_cvt_pk_bf16_f32 v73, v46, v47
    v_exp_f32 v48, v48
    v_exp_f32 v49, v49
    v_exp_f32 v50, v50
    v_exp_f32 v51, v51
    v_cvt_pk_bf16_f32 v74, v48, v49
    v_cvt_pk_bf16_f32 v75, v50, v51
    s_waitcnt vmcnt(48)
    v_perm_b32 v208, v145, v144, s72
    v_perm_b32 v209, v147, v146, s72
    v_perm_b32 v210, v149, v148, s72
    v_perm_b32 v211, v151, v150, s72
    buffer_store_dwordx4 v[208:211], v9, s[32:35], s63 offen offset:0 sc1
    v_perm_b32 v212, v145, v144, s73
    v_perm_b32 v213, v147, v146, s73
    v_perm_b32 v214, v149, v148, s73
    v_perm_b32 v215, v151, v150, s73
    buffer_store_dwordx4 v[212:215], v9, s[32:35], s63 offen offset:1024 sc1
    v_lshl_or_b32 v216, v153, 16, v152
    v_lshl_or_b32 v217, v155, 16, v154
    v_lshl_or_b32 v218, v157, 16, v156
    v_lshl_or_b32 v219, v159, 16, v158
    buffer_store_dwordx4 v[216:219], v9, s[32:35], s63 offen offset:2048 sc1
    s_add_u32 s63, s63, 3072
    s_waitcnt vmcnt(35)
    v_perm_b32 v220, v161, v160, s72
    v_perm_b32 v221, v163, v162, s72
    v_perm_b32 v222, v165, v164, s72
    v_perm_b32 v223, v167, v166, s72
    buffer_store_dwordx4 v[220:223], v9, s[32:35], s63 offen offset:0 sc1
    v_perm_b32 v224, v161, v160, s73
    v_perm_b32 v225, v163, v162, s73
    v_perm_b32 v226, v165, v164, s73
    v_perm_b32 v227, v167, v166, s73
    buffer_store_dwordx4 v[224:227], v9, s[32:35], s63 offen offset:1024 sc1
    v_lshl_or_b32 v228, v169, 16, v168
    v_lshl_or_b32 v229, v171, 16, v170
    v_lshl_or_b32 v230, v173, 16, v172
    v_lshl_or_b32 v231, v175, 16, v174
    buffer_store_dwordx4 v[228:231], v9, s[32:35], s63 offen offset:2048 sc1
    s_add_u32 s63, s63, 3072
    s_waitcnt vmcnt(22)
    v_perm_b32 v208, v177, v176, s72
    v_perm_b32 v209, v179, v178, s72
    v_perm_b32 v210, v181, v180, s72
    v_perm_b32 v211, v183, v182, s72
    buffer_store_dwordx4 v[208:211], v9, s[32:35], s63 offen offset:0 sc1
    v_perm_b32 v212, v177, v176, s73
    v_perm_b32 v213, v179, v178, s73
    v_perm_b32 v214, v181, v180, s73
    v_perm_b32 v215, v183, v182, s73
    buffer_store_dwordx4 v[212:215], v9, s[32:35], s63 offen offset:1024 sc1
    v_lshl_or_b32 v216, v185, 16, v184
    v_lshl_or_b32 v217, v187, 16, v186
    v_lshl_or_b32 v218, v189, 16, v188
    v_lshl_or_b32 v219, v191, 16, v190
    buffer_store_dwordx4 v[216:219], v9, s[32:35], s63 offen offset:2048 sc1
    s_add_u32 s63, s63, 3072
    s_waitcnt vmcnt(9)
    v_perm_b32 v220, v193, v192, s72
    v_perm_b32 v221, v195, v194, s72
    v_perm_b32 v222, v197, v196, s72
    v_perm_b32 v223, v199, v198, s72
    buffer_store_dwordx4 v[220:223], v9, s[32:35], s63 offen offset:0 sc1
    v_perm_b32 v224, v193, v192, s73
    v_perm_b32 v225, v195, v194, s73
    v_perm_b32 v226, v197, v196, s73
    v_perm_b32 v227, v199, v198, s73
    buffer_store_dwordx4 v[224:227], v9, s[32:35], s63 offen offset:1024 sc1
    v_lshl_or_b32 v228, v201, 16, v200
    v_lshl_or_b32 v229, v203, 16, v202
    v_lshl_or_b32 v230, v205, 16, v204
    v_lshl_or_b32 v231, v207, 16, v206
    buffer_store_dwordx4 v[228:231], v9, s[32:35], s63 offen offset:2048 sc1
    s_add_u32 s63, s63, 3072
    v_mov_b32 v232, -1
    v_mov_b32 v233, -1
    v_mov_b32 v234, -1
    v_mov_b32 v235, -1
    s_mul_i32 s46, s57, 73728
    s_mul_i32 s47, s40, 18432
    s_add_u32 s46, s46, s47
    s_mul_i32 s46, s40, 9216
    s_add_u32 s46, s46, 522240
    buffer_load_dwordx4 v[148:151], v9, s[32:35], s46 offen offset:0 sc1
    buffer_load_dwordx4 v[152:155], v9, s[32:35], s46 offen offset:1024 sc1
    buffer_load_dwordx4 v[156:159], v9, s[32:35], s46 offen offset:2048 sc1
    s_add_u32 s46, s46, 36864
    buffer_load_dwordx4 v[160:163], v9, s[32:35], s46 offen offset:0 sc1
    buffer_load_dwordx4 v[164:167], v9, s[32:35], s46 offen offset:1024 sc1
    buffer_load_dwordx4 v[168:171], v9, s[32:35], s46 offen offset:2048 sc1
    s_add_u32 s46, s46, 36864
    buffer_load_dwordx4 v[172:175], v9, s[32:35], s46 offen offset:0 sc1
    buffer_load_dwordx4 v[176:179], v9, s[32:35], s46 offen offset:1024 sc1
    buffer_load_dwordx4 v[180:183], v9, s[32:35], s46 offen offset:2048 sc1
    s_add_u32 s46, s46, 36864
    buffer_load_dwordx4 v[184:187], v9, s[32:35], s46 offen offset:0 sc1
    buffer_load_dwordx4 v[188:191], v9, s[32:35], s46 offen offset:1024 sc1
    buffer_load_dwordx4 v[192:195], v9, s[32:35], s46 offen offset:2048 sc1
    s_add_u32 s46, s46, 36864
    buffer_load_dwordx4 v[196:199], v9, s[32:35], s46 offen offset:0 sc1
    buffer_load_dwordx4 v[200:203], v9, s[32:35], s46 offen offset:1024 sc1
    buffer_load_dwordx4 v[204:207], v9, s[32:35], s46 offen offset:2048 sc1
    s_add_u32 s46, s46, 36864
    buffer_load_dwordx4 v[208:211], v9, s[32:35], s46 offen offset:0 sc1
    buffer_load_dwordx4 v[212:215], v9, s[32:35], s46 offen offset:1024 sc1
    buffer_load_dwordx4 v[216:219], v9, s[32:35], s46 offen offset:2048 sc1
    s_add_u32 s46, s46, 36864
    buffer_load_dwordx4 v[220:223], v9, s[32:35], s46 offen offset:0 sc1
    buffer_load_dwordx4 v[224:227], v9, s[32:35], s46 offen offset:1024 sc1
    buffer_load_dwordx4 v[228:231], v9, s[32:35], s46 offen offset:2048 sc1
    s_add_u32 s46, s46, 36864
    buffer_load_dwordx4 v[232:235], v9, s[32:35], s46 offen offset:0 sc1
    buffer_load_dwordx4 v[236:239], v9, s[32:35], s46 offen offset:1024 sc1
    buffer_load_dwordx4 v[240:243], v9, s[32:35], s46 offen offset:2048 sc1
    s_add_u32 s46, s46, 36864
    buffer_load_dwordx4 v[244:247], v9, s[32:35], s46 offen offset:0 sc1
    buffer_load_dwordx4 v[248:251], v9, s[32:35], s46 offen offset:1024 sc1
    buffer_load_dwordx4 v[252:255], v9, s[32:35], s46 offen offset:2048 sc1
    s_add_u32 s46, s46, 36864
    s_mov_b32 s36, s18
    s_and_b32 s37, s19, 0xffff
    s_mov_b32 s38, 9216
    s_mov_b32 s39, 0x00020000
    s_lshl_b32 s46, s40, 8
    s_mul_i32 s47, s43, 1152
    s_add_u32 s46, s46, s47
    v_lshlrev_b32 v5, 2, v1
    buffer_load_dword v140, v5, s[36:39], s46 offen
    buffer_load_dword v141, v5, s[36:39], s46 offen offset:1024
    v_mfma_f32_32x32x8_bf16 v[36:51], v[118:119], v[14:15], 0
    v_exp_f32 v52, v52
    v_exp_f32 v53, v53
    v_exp_f32 v54, v54
    v_exp_f32 v55, v55
    v_mfma_f32_32x32x16_bf16 v[76:91], v[128:131], v[72:75], v[76:91]
    v_cvt_pk_bf16_f32 v68, v52, v53
    v_cvt_pk_bf16_f32 v69, v54, v55
    v_exp_f32 v56, v56
    v_exp_f32 v57, v57
    v_exp_f32 v58, v58
    v_exp_f32 v59, v59
    v_mfma_f32_32x32x16_bf16 v[36:51], v[112:115], v[28:31], v[36:51]
    v_cvt_pk_bf16_f32 v70, v56, v57
    v_cvt_pk_bf16_f32 v71, v58, v59
    v_exp_f32 v60, v60
    v_exp_f32 v61, v61
    v_exp_f32 v62, v62
    v_exp_f32 v63, v63
    v_mfma_f32_32x32x16_bf16 v[92:107], v[124:127], v[68:71], v[92:107]
    v_cvt_pk_bf16_f32 v72, v60, v61
    v_cvt_pk_bf16_f32 v73, v62, v63
    v_exp_f32 v64, v64
    v_exp_f32 v65, v65
    v_exp_f32 v66, v66
    v_exp_f32 v67, v67
    v_cvt_pk_bf16_f32 v74, v64, v65
    v_cvt_pk_bf16_f32 v75, v66, v67
    s_waitcnt lgkmcnt(0)
    v_mfma_f32_32x32x8_bf16 v[52:67], v[118:119], v[18:19], 0
    v_exp_f32 v36, v36
    v_exp_f32 v37, v37
    v_exp_f32 v38, v38
    v_exp_f32 v39, v39
    v_mfma_f32_32x32x16_bf16 v[92:107], v[128:131], v[72:75], v[92:107]
    s_mov_b64 exec, s[8:9]
    ds_read_b128 v[124:127], v4 offset:18432
    ds_read_b128 v[128:131], v4 offset:19008
    s_mov_b64 exec, -1
    v_cvt_pk_bf16_f32 v68, v36, v37
    v_cvt_pk_bf16_f32 v69, v38, v39
    v_exp_f32 v40, v40
    v_exp_f32 v41, v41
    v_exp_f32 v42, v42
    v_exp_f32 v43, v43
    v_mfma_f32_32x32x16_bf16 v[52:67], v[112:115], v[32:35], v[52:67]
    ds_read_b128 v[112:115], v2 offset:19456
    v_cvt_pk_bf16_f32 v70, v40, v41
    v_cvt_pk_bf16_f32 v71, v42, v43
    v_exp_f32 v44, v44
    v_exp_f32 v45, v45
    v_exp_f32 v46, v46
    v_exp_f32 v47, v47
    v_mfma_f32_32x32x16_bf16 v[76:91], v[132:135], v[68:71], v[76:91]
    v_cvt_pk_bf16_f32 v72, v44, v45
    v_cvt_pk_bf16_f32 v73, v46, v47
    v_exp_f32 v48, v48
    v_exp_f32 v49, v49
    v_exp_f32 v50, v50
    v_exp_f32 v51, v51
    v_cvt_pk_bf16_f32 v74, v48, v49
    v_cvt_pk_bf16_f32 v75, v50, v51
    v_mfma_f32_32x32x8_bf16 v[36:51], v[120:121], v[12:13], 0
    v_exp_f32 v52, v52
    v_exp_f32 v53, v53
    v_exp_f32 v54, v54
    v_exp_f32 v55, v55
    v_mfma_f32_32x32x16_bf16 v[76:91], v[136:139], v[72:75], v[76:91]
    v_cvt_pk_bf16_f32 v68, v52, v53
    v_cvt_pk_bf16_f32 v69, v54, v55
    v_exp_f32 v56, v56
    v_exp_f32 v57, v57
    v_exp_f32 v58, v58
    v_exp_f32 v59, v59
    v_mfma_f32_32x32x16_bf16 v[36:51], v[108:111], v[28:31], v[36:51]
    v_cvt_pk_bf16_f32 v70, v56, v57
    v_cvt_pk_bf16_f32 v71, v58, v59
    v_exp_f32 v60, v60
    v_exp_f32 v61, v61
    v_exp_f32 v62, v62
    v_exp_f32 v63, v63
    v_mfma_f32_32x32x16_bf16 v[92:107], v[132:135], v[68:71], v[92:107]
    v_cvt_pk_bf16_f32 v72, v60, v61
    v_cvt_pk_bf16_f32 v73, v62, v63
    v_exp_f32 v64, v64
    v_exp_f32 v65, v65
    v_exp_f32 v66, v66
    v_exp_f32 v67, v67
    v_cvt_pk_bf16_f32 v74, v64, v65
    v_cvt_pk_bf16_f32 v75, v66, v67
    s_waitcnt lgkmcnt(0)
    v_mfma_f32_32x32x8_bf16 v[52:67], v[120:121], v[16:17], 0
    v_exp_f32 v36, v36
    v_exp_f32 v37, v37
    v_exp_f32 v38, v38
    v_exp_f32 v39, v39
    v_mfma_f32_32x32x16_bf16 v[92:107], v[136:139], v[72:75], v[92:107]
    s_mov_b64 exec, s[8:9]
    ds_read_b128 v[132:135], v4 offset:19584
    ds_read_b128 v[136:139], v4 offset:20160
    s_mov_b64 exec, -1
    v_cvt_pk_bf16_f32 v68, v36, v37
    v_cvt_pk_bf16_f32 v69, v38, v39
    v_exp_f32 v40, v40
    v_exp_f32 v41, v41
    v_exp_f32 v42, v42
    v_exp_f32 v43, v43
    v_mfma_f32_32x32x16_bf16 v[52:67], v[108:111], v[32:35], v[52:67]
    ds_read_b128 v[108:111], v2 offset:20480
    v_cvt_pk_bf16_f32 v70, v40, v41
    v_cvt_pk_bf16_f32 v71, v42, v43
    v_exp_f32 v44, v44
    v_exp_f32 v45, v45
    v_exp_f32 v46, v46
    v_exp_f32 v47, v47
    v_mfma_f32_32x32x16_bf16 v[76:91], v[124:127], v[68:71], v[76:91]
    v_cvt_pk_bf16_f32 v72, v44, v45
    v_cvt_pk_bf16_f32 v73, v46, v47
    v_exp_f32 v48, v48
    v_exp_f32 v49, v49
    v_exp_f32 v50, v50
    v_exp_f32 v51, v51
    v_cvt_pk_bf16_f32 v74, v48, v49
    v_cvt_pk_bf16_f32 v75, v50, v51
    v_mfma_f32_32x32x8_bf16 v[36:51], v[120:121], v[14:15], 0
    v_exp_f32 v52, v52
    v_exp_f32 v53, v53
    v_exp_f32 v54, v54
    v_exp_f32 v55, v55
    v_mfma_f32_32x32x16_bf16 v[76:91], v[128:131], v[72:75], v[76:91]
    v_cvt_pk_bf16_f32 v68, v52, v53
    v_cvt_pk_bf16_f32 v69, v54, v55
    v_exp_f32 v56, v56
    v_exp_f32 v57, v57
    v_exp_f32 v58, v58
    v_exp_f32 v59, v59
    v_mfma_f32_32x32x16_bf16 v[36:51], v[112:115], v[28:31], v[36:51]
    v_cvt_pk_bf16_f32 v70, v56, v57
    v_cvt_pk_bf16_f32 v71, v58, v59
    v_exp_f32 v60, v60
    v_exp_f32 v61, v61
    v_exp_f32 v62, v62
    v_exp_f32 v63, v63
    v_mfma_f32_32x32x16_bf16 v[92:107], v[124:127], v[68:71], v[92:107]
    v_cvt_pk_bf16_f32 v72, v60, v61
    v_cvt_pk_bf16_f32 v73, v62, v63
    v_exp_f32 v64, v64
    v_exp_f32 v65, v65
    v_exp_f32 v66, v66
    v_exp_f32 v67, v67
    v_cvt_pk_bf16_f32 v74, v64, v65
    v_cvt_pk_bf16_f32 v75, v66, v67
    s_waitcnt lgkmcnt(0)
    v_mfma_f32_32x32x8_bf16 v[52:67], v[120:121], v[18:19], 0
    s_mov_b64 exec, s[50:51]
    ds_read_b128 v[116:119], v2 offset:40960
    s_mov_b64 exec, -1
    v_exp_f32 v36, v36
    v_exp_f32 v37, v37
    v_exp_f32 v38, v38
    v_exp_f32 v39, v39
    v_mfma_f32_32x32x16_bf16 v[92:107], v[128:131], v[72:75], v[92:107]
    s_mov_b64 exec, s[8:9]
    ds_read_b128 v[124:127], v4 offset:20736
    ds_read_b128 v[128:131], v4 offset:21312
    s_mov_b64 exec, -1
    v_cvt_pk_bf16_f32 v68, v36, v37
    v_cvt_pk_bf16_f32 v69, v38, v39
    v_exp_f32 v40, v40
    v_exp_f32 v41, v41
    v_exp_f32 v42, v42
    v_exp_f32 v43, v43
    v_mfma_f32_32x32x16_bf16 v[52:67], v[112:115], v[32:35], v[52:67]
    ds_read_b128 v[112:115], v2 offset:21504
    v_cvt_pk_bf16_f32 v70, v40, v41
    v_cvt_pk_bf16_f32 v71, v42, v43
    v_exp_f32 v44, v44
    v_exp_f32 v45, v45
    v_exp_f32 v46, v46
    v_exp_f32 v47, v47
    v_mfma_f32_32x32x16_bf16 v[76:91], v[132:135], v[68:71], v[76:91]
    v_cvt_pk_bf16_f32 v72, v44, v45
    v_cvt_pk_bf16_f32 v73, v46, v47
    v_exp_f32 v48, v48
    v_exp_f32 v49, v49
    v_exp_f32 v50, v50
    v_exp_f32 v51, v51
    v_cvt_pk_bf16_f32 v74, v48, v49
    v_cvt_pk_bf16_f32 v75, v50, v51
    s_setprio 1
    v_mfma_f32_32x32x8_bf16 v[36:51], v[122:123], v[12:13], 0
    v_exp_f32 v52, v52
    v_exp_f32 v53, v53
    v_exp_f32 v54, v54
    v_exp_f32 v55, v55
    v_mfma_f32_32x32x16_bf16 v[76:91], v[136:139], v[72:75], v[76:91]
    v_cvt_pk_bf16_f32 v68, v52, v53
    v_cvt_pk_bf16_f32 v69, v54, v55
    v_exp_f32 v56, v56
    v_exp_f32 v57, v57
    v_exp_f32 v58, v58
    v_exp_f32 v59, v59
    v_mfma_f32_32x32x16_bf16 v[36:51], v[108:111], v[28:31], v[36:51]
    v_cvt_pk_bf16_f32 v70, v56, v57
    v_cvt_pk_bf16_f32 v71, v58, v59
    v_exp_f32 v60, v60
    v_exp_f32 v61, v61
    v_exp_f32 v62, v62
    v_exp_f32 v63, v63
    v_mfma_f32_32x32x16_bf16 v[92:107], v[132:135], v[68:71], v[92:107]
    v_cvt_pk_bf16_f32 v72, v60, v61
    v_cvt_pk_bf16_f32 v73, v62, v63
    v_exp_f32 v64, v64
    v_exp_f32 v65, v65
    v_exp_f32 v66, v66
    v_exp_f32 v67, v67
    v_cvt_pk_bf16_f32 v74, v64, v65
    v_cvt_pk_bf16_f32 v75, v66, v67
    s_waitcnt lgkmcnt(0)
    v_mfma_f32_32x32x8_bf16 v[52:67], v[122:123], v[16:17], 0
    v_exp_f32 v36, v36
    v_exp_f32 v37, v37
    v_exp_f32 v38, v38
    v_exp_f32 v39, v39
    v_mfma_f32_32x32x16_bf16 v[92:107], v[136:139], v[72:75], v[92:107]
    s_mov_b64 exec, s[8:9]
    ds_read_b128 v[132:135], v4 offset:21888
    ds_read_b128 v[136:139], v4 offset:22464
    s_mov_b64 exec, -1
    v_cvt_pk_bf16_f32 v68, v36, v37
    v_cvt_pk_bf16_f32 v69, v38, v39
    v_exp_f32 v40, v40
    v_exp_f32 v41, v41
    v_exp_f32 v42, v42
    v_exp_f32 v43, v43
    v_mfma_f32_32x32x16_bf16 v[52:67], v[108:111], v[32:35], v[52:67]
    ds_read_b128 v[108:111], v2 offset:36864
    v_cvt_pk_bf16_f32 v70, v40, v41
    v_cvt_pk_bf16_f32 v71, v42, v43
    v_exp_f32 v44, v44
    v_exp_f32 v45, v45
    v_exp_f32 v46, v46
    v_exp_f32 v47, v47
    v_mfma_f32_32x32x16_bf16 v[76:91], v[124:127], v[68:71], v[76:91]
    v_cvt_pk_bf16_f32 v72, v44, v45
    v_cvt_pk_bf16_f32 v73, v46, v47
    v_exp_f32 v48, v48
    v_exp_f32 v49, v49
    v_exp_f32 v50, v50
    v_exp_f32 v51, v51
    v_cvt_pk_bf16_f32 v74, v48, v49
    v_cvt_pk_bf16_f32 v75, v50, v51
    v_mfma_f32_32x32x8_bf16 v[36:51], v[122:123], v[14:15], 0
    v_exp_f32 v52, v52
    v_exp_f32 v53, v53
    v_exp_f32 v54, v54
    v_exp_f32 v55, v55
    v_mfma_f32_32x32x16_bf16 v[76:91], v[128:131], v[72:75], v[76:91]
    v_cvt_pk_bf16_f32 v68, v52, v53
    v_cvt_pk_bf16_f32 v69, v54, v55
    v_exp_f32 v56, v56
    v_exp_f32 v57, v57
    v_exp_f32 v58, v58
    v_exp_f32 v59, v59
    v_mfma_f32_32x32x16_bf16 v[36:51], v[112:115], v[28:31], v[36:51]
    v_cvt_pk_bf16_f32 v70, v56, v57
    v_cvt_pk_bf16_f32 v71, v58, v59
    v_exp_f32 v60, v60
    v_exp_f32 v61, v61
    v_exp_f32 v62, v62
    v_exp_f32 v63, v63
    v_mfma_f32_32x32x16_bf16 v[92:107], v[124:127], v[68:71], v[92:107]
    v_cvt_pk_bf16_f32 v72, v60, v61
    v_cvt_pk_bf16_f32 v73, v62, v63
    v_exp_f32 v64, v64
    v_exp_f32 v65, v65
    v_exp_f32 v66, v66
    v_exp_f32 v67, v67
    v_cvt_pk_bf16_f32 v74, v64, v65
    v_cvt_pk_bf16_f32 v75, v66, v67
    s_waitcnt lgkmcnt(0)
    v_mfma_f32_32x32x8_bf16 v[52:67], v[122:123], v[18:19], 0
    v_exp_f32 v36, v36
    v_exp_f32 v37, v37
    v_exp_f32 v38, v38
    v_exp_f32 v39, v39
    v_mfma_f32_32x32x16_bf16 v[92:107], v[128:131], v[72:75], v[92:107]
    s_mov_b64 exec, s[8:9]
    ds_read_b128 v[124:127], v4 offset:36864
    ds_read_b128 v[128:131], v4 offset:37440
    s_mov_b64 exec, -1
    v_cvt_pk_bf16_f32 v68, v36, v37
    v_cvt_pk_bf16_f32 v69, v38, v39
    v_exp_f32 v40, v40
    v_exp_f32 v41, v41
    v_exp_f32 v42, v42
    v_exp_f32 v43, v43
    v_mfma_f32_32x32x16_bf16 v[52:67], v[112:115], v[32:35], v[52:67]
    ds_read_b128 v[112:115], v2 offset:37888
    v_cvt_pk_bf16_f32 v70, v40, v41
    v_cvt_pk_bf16_f32 v71, v42, v43
    v_exp_f32 v44, v44
    v_exp_f32 v45, v45
    v_exp_f32 v46, v46
    v_exp_f32 v47, v47
    v_mfma_f32_32x32x16_bf16 v[76:91], v[132:135], v[68:71], v[76:91]
    v_cvt_pk_bf16_f32 v72, v44, v45
    v_cvt_pk_bf16_f32 v73, v46, v47
    v_exp_f32 v48, v48
    v_exp_f32 v49, v49
    v_exp_f32 v50, v50
    v_exp_f32 v51, v51
    v_cvt_pk_bf16_f32 v74, v48, v49
    v_cvt_pk_bf16_f32 v75, v50, v51
    v_mfma_f32_32x32x8_bf16 v[36:51], v[116:117], v[12:13], 0
    v_exp_f32 v52, v52
    v_exp_f32 v53, v53
    v_exp_f32 v54, v54
    v_exp_f32 v55, v55
    v_mfma_f32_32x32x16_bf16 v[76:91], v[136:139], v[72:75], v[76:91]
    v_cvt_pk_bf16_f32 v68, v52, v53
    v_cvt_pk_bf16_f32 v69, v54, v55
    v_exp_f32 v56, v56
    v_exp_f32 v57, v57
    v_exp_f32 v58, v58
    v_exp_f32 v59, v59
    v_mfma_f32_32x32x16_bf16 v[36:51], v[108:111], v[28:31], v[36:51]
    v_cvt_pk_bf16_f32 v70, v56, v57
    v_cvt_pk_bf16_f32 v71, v58, v59
    v_exp_f32 v60, v60
    v_exp_f32 v61, v61
    v_exp_f32 v62, v62
    v_exp_f32 v63, v63
    v_mfma_f32_32x32x16_bf16 v[92:107], v[132:135], v[68:71], v[92:107]
    v_cvt_pk_bf16_f32 v72, v60, v61
    v_cvt_pk_bf16_f32 v73, v62, v63
    v_exp_f32 v64, v64
    v_exp_f32 v65, v65
    v_exp_f32 v66, v66
    v_exp_f32 v67, v67
    v_cvt_pk_bf16_f32 v74, v64, v65
    v_cvt_pk_bf16_f32 v75, v66, v67
    s_waitcnt vmcnt(29)
    v_mov_b32 v5, 163348
    v_mov_b32 v6, 1
    s_mov_b64 exec, 1
    ds_add_u32 v5, v6
    s_mov_b64 exec, -1
    s_mov_b64 vcc, 0
    s_branch L_a_loop_end
L_a_fallback:
    s_cmp_lg_u32 s10, 0
    s_cselect_b64 vcc, -1, 0
    v_cndmask_b32 v28, v28, v32, vcc
    v_cndmask_b32 v29, v29, v33, vcc
    v_cndmask_b32 v30, v30, v34, vcc
    v_cndmask_b32 v31, v31, v35, vcc
    v_cndmask_b32 v12, v12, v16, vcc
    v_cndmask_b32 v12, 0, v12, s[50:51]
    v_mov_b32 v15, v12
    v_mov_b32 v5, 0xff800000
    v_subrev_u32 v2, s11, v2
    v_subrev_u32 v4, s11, v4
    v_subrev_u32 v2, 147456, v2
    v_subrev_u32 v4, 147456, v4
    s_mov_b32 s48, 0
L_a_fb0:
    s_mov_b64 exec, s[50:51]
    ds_read_b128 v[116:119], v2 offset:4096
    s_mov_b64 exec, -1
    ds_read_b128 v[108:111], v2 offset:0
    s_waitcnt lgkmcnt(0)
    v_mfma_f32_32x32x8_bf16 v[52:67], v[116:117], v[12:13], 0
    s_nop 9
    v_mfma_f32_32x32x16_bf16 v[52:67], v[108:111], v[28:31], v[52:67]
    s_nop 11
    v_max3_f32 v5, v52, v53, v5
    v_max3_f32 v5, v54, v55, v5
    v_max3_f32 v5, v56, v57, v5
    v_max3_f32 v5, v58, v59, v5
    v_max3_f32 v5, v60, v61, v5
    v_max3_f32 v5, v62, v63, v5
    v_max3_f32 v5, v64, v65, v5
    v_max3_f32 v5, v66, v67, v5
    ds_read_b128 v[108:111], v2 offset:1024
    s_waitcnt lgkmcnt(0)
    v_mfma_f32_32x32x8_bf16 v[52:67], v[116:117], v[14:15], 0
    s_nop 9
    v_mfma_f32_32x32x16_bf16 v[52:67], v[108:111], v[28:31], v[52:67]
    s_nop 11
    v_max3_f32 v5, v52, v53, v5
    v_max3_f32 v5, v54, v55, v5
    v_max3_f32 v5, v56, v57, v5
    v_max3_f32 v5, v58, v59, v5
    v_max3_f32 v5, v60, v61, v5
    v_max3_f32 v5, v62, v63, v5
    v_max3_f32 v5, v64, v65, v5
    v_max3_f32 v5, v66, v67, v5
    ds_read_b128 v[108:111], v2 offset:2048
    s_waitcnt lgkmcnt(0)
    v_mfma_f32_32x32x8_bf16 v[52:67], v[118:119], v[12:13], 0
    s_nop 9
    v_mfma_f32_32x32x16_bf16 v[52:67], v[108:111], v[28:31], v[52:67]
    s_nop 11
    v_max3_f32 v5, v52, v53, v5
    v_max3_f32 v5, v54, v55, v5
    v_max3_f32 v5, v56, v57, v5
    v_max3_f32 v5, v58, v59, v5
    v_max3_f32 v5, v60, v61, v5
    v_max3_f32 v5, v62, v63, v5
    v_max3_f32 v5, v64, v65, v5
    v_max3_f32 v5, v66, v67, v5
    ds_read_b128 v[108:111], v2 offset:3072
    s_waitcnt lgkmcnt(0)
    v_mfma_f32_32x32x8_bf16 v[52:67], v[118:119], v[14:15], 0
    s_nop 9
    v_mfma_f32_32x32x16_bf16 v[52:67], v[108:111], v[28:31], v[52:67]
    s_nop 11
    v_max3_f32 v5, v52, v53, v5
    v_max3_f32 v5, v54, v55, v5
    v_max3_f32 v5, v56, v57, v5
    v_max3_f32 v5, v58, v59, v5
    v_max3_f32 v5, v60, v61, v5
    v_max3_f32 v5, v62, v63, v5
    v_max3_f32 v5, v64, v65, v5
    v_max3_f32 v5, v66, v67, v5
    v_add_u32 v2, 9216, v2
    v_add_u32 v4, 9216, v4
    s_add_u32 s48, s48, 1
    s_cmp_lt_u32 s48, 16
    s_cbranch_scc1 L_a_fb0
    v_mov_b32 v6, v5
    s_nop 1
    v_permlane32_swap_b32 v5, v6
    v_max_f32 v5, v5, v6
    v_mov_b32 v76, 0
    v_mov_b32 v77, 0
    v_mov_b32 v78, 0
    v_mov_b32 v79, 0
    v_mov_b32 v80, 0
    v_mov_b32 v81, 0
    v_mov_b32 v82, 0
    v_mov_b32 v83, 0
    v_mov_b32 v84, 0
    v_mov_b32 v85, 0
    v_mov_b32 v86, 0
    v_mov_b32 v87, 0
    v_mov_b32 v88, 0
    v_mov_b32 v89, 0
    v_mov_b32 v90, 0
    v_mov_b32 v91, 0
    v_subrev_u32 v2, 147456, v2
    v_subrev_u32 v4, 147456, v4
    s_mov_b32 s48, 0
L_a_fb1:
    s_mov_b64 exec, s[50:51]
    ds_read_b128 v[116:119], v2 offset:4096
    s_mov_b64 exec, -1
    ds_read_b128 v[108:111], v2 offset:0
    s_mov_b64 exec, s[8:9]
    ds_read_b128 v[124:127], v4 offset:0
    ds_read_b128 v[128:131], v4 offset:576
    s_mov_b64 exec, -1
    s_waitcnt lgkmcnt(0)
    v_mfma_f32_32x32x8_bf16 v[52:67], v[116:117], v[12:13], 0
    s_nop 9
    v_mfma_f32_32x32x16_bf16 v[52:67], v[108:111], v[28:31], v[52:67]
    s_nop 11
    v_sub_f32 v52, v52, v5
    v_sub_f32 v53, v53, v5
    v_sub_f32 v54, v54, v5
    v_sub_f32 v55, v55, v5
    v_sub_f32 v56, v56, v5
    v_sub_f32 v57, v57, v5
    v_sub_f32 v58, v58, v5
    v_sub_f32 v59, v59, v5
    v_sub_f32 v60, v60, v5
    v_sub_f32 v61, v61, v5
    v_sub_f32 v62, v62, v5
    v_sub_f32 v63, v63, v5
    v_sub_f32 v64, v64, v5
    v_sub_f32 v65, v65, v5
    v_sub_f32 v66, v66, v5
    v_sub_f32 v67, v67, v5
    v_exp_f32 v52, v52
    v_exp_f32 v53, v53
    v_exp_f32 v54, v54
    v_exp_f32 v55, v55
    v_exp_f32 v56, v56
    v_exp_f32 v57, v57
    v_exp_f32 v58, v58
    v_exp_f32 v59, v59
    v_exp_f32 v60, v60
    v_exp_f32 v61, v61
    v_exp_f32 v62, v62
    v_exp_f32 v63, v63
    v_exp_f32 v64, v64
    v_exp_f32 v65, v65
    v_exp_f32 v66, v66
    v_exp_f32 v67, v67
    v_cvt_pk_bf16_f32 v68, v52, v53
    v_cvt_pk_bf16_f32 v69, v54, v55
    v_cvt_pk_bf16_f32 v70, v56, v57
    v_cvt_pk_bf16_f32 v71, v58, v59
    v_cvt_pk_bf16_f32 v72, v60, v61
    v_cvt_pk_bf16_f32 v73, v62, v63
    v_cvt_pk_bf16_f32 v74, v64, v65
    v_cvt_pk_bf16_f32 v75, v66, v67
    v_mfma_f32_32x32x16_bf16 v[76:91], v[124:127], v[68:71], v[76:91]
    s_nop 0
    v_mfma_f32_32x32x16_bf16 v[76:91], v[128:131], v[72:75], v[76:91]
    s_nop 7
    ds_read_b128 v[108:111], v2 offset:1024
    s_mov_b64 exec, s[8:9]
    ds_read_b128 v[124:127], v4 offset:1152
    ds_read_b128 v[128:131], v4 offset:1728
    s_mov_b64 exec, -1
    s_waitcnt lgkmcnt(0)
    v_mfma_f32_32x32x8_bf16 v[52:67], v[116:117], v[14:15], 0
    s_nop 9
    v_mfma_f32_32x32x16_bf16 v[52:67], v[108:111], v[28:31], v[52:67]
    s_nop 11
    v_sub_f32 v52, v52, v5
    v_sub_f32 v53, v53, v5
    v_sub_f32 v54, v54, v5
    v_sub_f32 v55, v55, v5
    v_sub_f32 v56, v56, v5
    v_sub_f32 v57, v57, v5
    v_sub_f32 v58, v58, v5
    v_sub_f32 v59, v59, v5
    v_sub_f32 v60, v60, v5
    v_sub_f32 v61, v61, v5
    v_sub_f32 v62, v62, v5
    v_sub_f32 v63, v63, v5
    v_sub_f32 v64, v64, v5
    v_sub_f32 v65, v65, v5
    v_sub_f32 v66, v66, v5
    v_sub_f32 v67, v67, v5
    v_exp_f32 v52, v52
    v_exp_f32 v53, v53
    v_exp_f32 v54, v54
    v_exp_f32 v55, v55
    v_exp_f32 v56, v56
    v_exp_f32 v57, v57
    v_exp_f32 v58, v58
    v_exp_f32 v59, v59
    v_exp_f32 v60, v60
    v_exp_f32 v61, v61
    v_exp_f32 v62, v62
    v_exp_f32 v63, v63
    v_exp_f32 v64, v64
    v_exp_f32 v65, v65
    v_exp_f32 v66, v66
    v_exp_f32 v67, v67
    v_cvt_pk_bf16_f32 v68, v52, v53
    v_cvt_pk_bf16_f32 v69, v54, v55
    v_cvt_pk_bf16_f32 v70, v56, v57
    v_cvt_pk_bf16_f32 v71, v58, v59
    v_cvt_pk_bf16_f32 v72, v60, v61
    v_cvt_pk_bf16_f32 v73, v62, v63
    v_cvt_pk_bf16_f32 v74, v64, v65
    v_cvt_pk_bf16_f32 v75, v66, v67
    v_mfma_f32_32x32x16_bf16 v[76:91], v[124:127], v[68:71], v[76:91]
    s_nop 0
    v_mfma_f32_32x32x16_bf16 v[76:91], v[128:131], v[72:75], v[76:91]
    s_nop 7
    ds_read_b128 v[108:111], v2 offset:2048
    s_mov_b64 exec, s[8:9]
    ds_read_b128 v[124:127], v4 offset:2304
    ds_read_b128 v[128:131], v4 offset:2880
    s_mov_b64 exec, -1
    s_waitcnt lgkmcnt(0)
    v_mfma_f32_32x32x8_bf16 v[52:67], v[118:119], v[12:13], 0
    s_nop 9
    v_mfma_f32_32x32x16_bf16 v[52:67], v[108:111], v[28:31], v[52:67]
    s_nop 11
    v_sub_f32 v52, v52, v5
    v_sub_f32 v53, v53, v5
    v_sub_f32 v54, v54, v5
    v_sub_f32 v55, v55, v5
    v_sub_f32 v56, v56, v5
    v_sub_f32 v57, v57, v5
    v_sub_f32 v58, v58, v5
    v_sub_f32 v59, v59, v5
    v_sub_f32 v60, v60, v5
    v_sub_f32 v61, v61, v5
    v_sub_f32 v62, v62, v5
    v_sub_f32 v63, v63, v5
    v_sub_f32 v64, v64, v5
    v_sub_f32 v65, v65, v5
    v_sub_f32 v66, v66, v5
    v_sub_f32 v67, v67, v5
    v_exp_f32 v52, v52
    v_exp_f32 v53, v53
    v_exp_f32 v54, v54
    v_exp_f32 v55, v55
    v_exp_f32 v56, v56
    v_exp_f32 v57, v57
    v_exp_f32 v58, v58
    v_exp_f32 v59, v59
    v_exp_f32 v60, v60
    v_exp_f32 v61, v61
    v_exp_f32 v62, v62
    v_exp_f32 v63, v63
    v_exp_f32 v64, v64
    v_exp_f32 v65, v65
    v_exp_f32 v66, v66
    v_exp_f32 v67, v67
    v_cvt_pk_bf16_f32 v68, v52, v53
    v_cvt_pk_bf16_f32 v69, v54, v55
    v_cvt_pk_bf16_f32 v70, v56, v57
    v_cvt_pk_bf16_f32 v71, v58, v59
    v_cvt_pk_bf16_f32 v72, v60, v61
    v_cvt_pk_bf16_f32 v73, v62, v63
    v_cvt_pk_bf16_f32 v74, v64, v65
    v_cvt_pk_bf16_f32 v75, v66, v67
    v_mfma_f32_32x32x16_bf16 v[76:91], v[124:127], v[68:71], v[76:91]
    s_nop 0
    v_mfma_f32_32x32x16_bf16 v[76:91], v[128:131], v[72:75], v[76:91]
    s_nop 7
    ds_read_b128 v[108:111], v2 offset:3072
    s_mov_b64 exec, s[8:9]
    ds_read_b128 v[124:127], v4 offset:3456
    ds_read_b128 v[128:131], v4 offset:4032
    s_mov_b64 exec, -1
    s_waitcnt lgkmcnt(0)
    v_mfma_f32_32x32x8_bf16 v[52:67], v[118:119], v[14:15], 0
    s_nop 9
    v_mfma_f32_32x32x16_bf16 v[52:67], v[108:111], v[28:31], v[52:67]
    s_nop 11
    v_sub_f32 v52, v52, v5
    v_sub_f32 v53, v53, v5
    v_sub_f32 v54, v54, v5
    v_sub_f32 v55, v55, v5
    v_sub_f32 v56, v56, v5
    v_sub_f32 v57, v57, v5
    v_sub_f32 v58, v58, v5
    v_sub_f32 v59, v59, v5
    v_sub_f32 v60, v60, v5
    v_sub_f32 v61, v61, v5
    v_sub_f32 v62, v62, v5
    v_sub_f32 v63, v63, v5
    v_sub_f32 v64, v64, v5
    v_sub_f32 v65, v65, v5
    v_sub_f32 v66, v66, v5
    v_sub_f32 v67, v67, v5
    v_exp_f32 v52, v52
    v_exp_f32 v53, v53
    v_exp_f32 v54, v54
    v_exp_f32 v55, v55
    v_exp_f32 v56, v56
    v_exp_f32 v57, v57
    v_exp_f32 v58, v58
    v_exp_f32 v59, v59
    v_exp_f32 v60, v60
    v_exp_f32 v61, v61
    v_exp_f32 v62, v62
    v_exp_f32 v63, v63
    v_exp_f32 v64, v64
    v_exp_f32 v65, v65
    v_exp_f32 v66, v66
    v_exp_f32 v67, v67
    v_cvt_pk_bf16_f32 v68, v52, v53
    v_cvt_pk_bf16_f32 v69, v54, v55
    v_cvt_pk_bf16_f32 v70, v56, v57
    v_cvt_pk_bf16_f32 v71, v58, v59
    v_cvt_pk_bf16_f32 v72, v60, v61
    v_cvt_pk_bf16_f32 v73, v62, v63
    v_cvt_pk_bf16_f32 v74, v64, v65
    v_cvt_pk_bf16_f32 v75, v66, v67
    v_mfma_f32_32x32x16_bf16 v[76:91], v[124:127], v[68:71], v[76:91]
    s_nop 0
    v_mfma_f32_32x32x16_bf16 v[76:91], v[128:131], v[72:75], v[76:91]
    s_nop 7
    v_add_u32 v2, 9216, v2
    v_add_u32 v4, 9216, v4
    s_add_u32 s48, s48, 1
    s_cmp_lt_u32 s48, 16
    s_cbranch_scc1 L_a_fb1
    s_nop 7
    v_rcp_f32 v6, v86
    v_cndmask_b32 v92, 0, v76, vcc
    v_cndmask_b32 v76, v76, 0, vcc
    v_cndmask_b32 v93, 0, v77, vcc
    v_cndmask_b32 v77, v77, 0, vcc
    v_cndmask_b32 v94, 0, v78, vcc
    v_cndmask_b32 v78, v78, 0, vcc
    v_cndmask_b32 v95, 0, v79, vcc
    v_cndmask_b32 v79, v79, 0, vcc
    v_cndmask_b32 v96, 0, v80, vcc
    v_cndmask_b32 v80, v80, 0, vcc
    v_cndmask_b32 v97, 0, v81, vcc
    v_cndmask_b32 v81, v81, 0, vcc
    v_cndmask_b32 v98, 0, v82, vcc
    v_cndmask_b32 v82, v82, 0, vcc
    v_cndmask_b32 v99, 0, v83, vcc
    v_cndmask_b32 v83, v83, 0, vcc
    v_cndmask_b32 v100, 0, v84, vcc
    v_cndmask_b32 v84, v84, 0, vcc
    v_cndmask_b32 v101, 0, v85, vcc
    v_cndmask_b32 v85, v85, 0, vcc
    v_mov_b32 v7, v6
    s_branch L_a_norm
L_m_roleA:
    v_add_u32 v3, 0, v2
    v_add_u32 v4, 36864, v2
    v_and_b32 v9, 15, v1
    v_lshlrev_b32 v9, 4, v9
    v_bfe_u32 v14, v1, 3, 1
    s_mov_b32 s46, 73728
    v_mul_lo_u32 v14, v14, s46
    v_lshl_add_u32 v14, v5, 4, v14
    v_and_b32 v15, 1, v6
    s_mov_b32 s46, 147456
    v_mul_lo_u32 v15, v15, s46
    v_add_u32 v15, v15, v14
    v_lshrrev_b32 v10, 1, v6
    v_lshl_add_u32 v15, v10, 7, v15
    v_lshl_add_u32 v14, v6, 7, v14
    s_lshl_b32 s46, s40, 8
    v_add_u32 v15, s46, v15
    s_lshl_b32 s46, s40, 9
    v_add_u32 v14, s46, v14
    s_lshl_b32 s71, s56, 6
    s_add_u32 s71, s71, s43
    s_mul_i32 s71, s71, 9216
    s_add_u32 s71, s71, 16908288
    s_mul_i32 s59, s40, 18432
    s_setprio 3
    s_waitcnt lgkmcnt(0)
    s_barrier
    s_mov_b32 s68, 0
    s_mul_i32 s46, s68, 768
    s_lshl_b32 s47, s40, 6
    s_add_u32 s46, s46, s47
    s_add_u32 s46, s46, 147456
    s_add_u32 s47, s46, s47
    v_lshl_add_u32 v11, v6, 5, s47
    v_lshl_add_u32 v12, v6, 4, s46
    ds_read_b128 v[16:19], v11 offset:2304
    ds_read_b128 v[20:23], v11 offset:2320
    ds_read_b128 v[24:27], v12 offset:512
    s_mov_b32 s69, 3
    s_call_b64 s[74:75], L_m_pass
    s_setprio 1
    s_mov_b32 s68, 2
    s_mul_i32 s46, s68, 768
    s_lshl_b32 s47, s40, 6
    s_add_u32 s46, s46, s47
    s_add_u32 s46, s46, 147456
    s_add_u32 s47, s46, s47
    v_lshl_add_u32 v11, v6, 5, s47
    v_lshl_add_u32 v12, v6, 4, s46
    ds_read_b128 v[16:19], v11 offset:2304
    ds_read_b128 v[20:23], v11 offset:2320
    ds_read_b128 v[24:27], v12 offset:512
    ds_read_b128 v[184:187], v3 offset:0
    ds_read_b128 v[188:191], v3 offset:1024
    ds_read_b128 v[192:195], v3 offset:2048
    ds_read_b128 v[196:199], v3 offset:3072
    ds_read_b128 v[200:203], v3 offset:4096
    ds_read_b128 v[204:207], v3 offset:5120
    ds_read_b128 v[208:211], v3 offset:6144
    ds_read_b128 v[212:215], v3 offset:7168
    s_mov_b32 s68, 0
    s_call_b64 s[74:75], L_m_gelu
    s_mov_b32 s68, 2
    s_mov_b32 s69, 0
    s_call_b64 s[74:75], L_m_pass_nb
    s_barrier
    s_mov_b32 s69, 16
    s_call_b64 s[74:75], L_m_gelu
    s_waitcnt lgkmcnt(0)
    s_barrier
    s_setprio 2
    v_add_u32 v7, s59, v2
    v_add_u32 v3, 73728, v3
    v_add_u32 v4, 73728, v4
    v_mov_b32 v16, 0
    v_mov_b32 v17, 0
    v_mov_b32 v18, 0
    v_mov_b32 v19, 0
    v_mov_b32 v20, 0
    v_mov_b32 v21, 0
    v_mov_b32 v22, 0
    v_mov_b32 v23, 0
    v_mov_b32 v24, 0
    v_mov_b32 v25, 0
    v_mov_b32 v26, 0
    v_mov_b32 v27, 0
    s_mov_b32 s69, 8
    s_mov_b32 s68, 1
    s_call_b64 s[74:75], L_m_pass
    s_setprio 0
    s_mov_b32 s36, s22
    s_and_b32 s37, s23, 0xffff
    s_mov_b32 s38, 1152
    s_mov_b32 s39, 0x00020000
    s_mov_b32 s24, s6
    s_and_b32 s25, s7, 0xffff
    s_mov_b32 s26, 2359296
    s_mov_b32 s27, 0x00020000
    s_mov_b32 s76, 0xffff0000
    s_mov_b32 s77, 0x40088e99
    s_lshl_b32 s46, s57, 7
    s_add_u32 s53, s46, 892928
    v_lshlrev_b32 v8, 4, v5
    s_call_b64 s[74:75], L_m_cvt
    s_call_b64 s[74:75], L_m_st
    s_barrier
    s_waitcnt vmcnt(0)
    v_mov_b32 v11, 163356
    v_mov_b32 v12, 1
    s_mov_b64 exec, 1
    ds_add_rtn_u32 v13, v11, v12
    s_mov_b64 exec, -1
    s_lshl_b32 s46, s56, 10
    s_lshl_b32 s47, s43, 4
    s_add_u32 s46, s46, s47
    s_add_u32 s46, s46, 925696
    v_lshlrev_b32 v11, 7, v1
    s_waitcnt lgkmcnt(0)
    v_readfirstlane_b32 s47, v13
    v_mov_b32 v12, s30
    s_cmp_lg_u32 s47, 3
    s_cbranch_scc1 L_pf_a
    s_mov_b64 exec, 0xff
    buffer_store_dword v12, v11, s[32:35], s46 offen sc1
    s_mov_b64 exec, -1
L_pf_a:
    s_add_u32 s52, s53, 32768
    s_mov_b64 vcc, -1
    s_cmp_eq_u32 s40, 3
    s_cbranch_scc1 L_r_st1
    s_mov_b32 s48, s40
    s_call_b64 s[74:75], L_r_init
    s_mov_b32 s49, 16384
L_r_poll0:
    buffer_load_dword v13, v8, s[32:35], s53 offen sc1
    s_waitcnt vmcnt(0)
    v_cmp_ne_u32 vcc, s30, v13
    s_sub_u32 s49, s49, 1
    s_cbranch_scc1 L_r_poll0_ok
    s_nop 1
    s_cmp_eq_u64 vcc, 0
    s_cbranch_scc1 L_r_poll0_ok
    s_sleep 4
    s_branch L_r_poll0
L_r_poll0_ok:
    s_call_b64 s[74:75], L_r_item
    s_cmp_eq_u32 s40, 0
    s_cbranch_scc1 L_m_done
    s_waitcnt vmcnt(1)
    v_cmp_ne_u32 vcc, s30, v7
L_r_st1:
    s_add_u32 s48, s40, 2
    s_call_b64 s[74:75], L_r_init
    s_cmp_eq_u64 vcc, 0
    s_cbranch_scc1 L_r_poll1_ok
    s_mov_b32 s49, 16384
L_r_poll1:
    buffer_load_dword v13, v8, s[32:35], s52 offen sc1
    s_waitcnt vmcnt(0)
    v_cmp_ne_u32 vcc, s30, v13
    s_sub_u32 s49, s49, 1
    s_cbranch_scc1 L_r_poll1_ok
    s_nop 1
    s_cmp_eq_u64 vcc, 0
    s_cbranch_scc1 L_r_poll1_ok
    s_sleep 4
    s_branch L_r_poll1
L_r_poll1_ok:
    s_call_b64 s[74:75], L_r_item
    s_branch L_m_done
L_m_roleB:
    buffer_load_dwordx4 v[28:31], v2, s[64:67], s70 offen offset:0 sc1
    buffer_load_dwordx4 v[32:35], v2, s[64:67], s70 offen offset:1024 sc1
    buffer_load_dwordx4 v[36:39], v2, s[64:67], s70 offen offset:2048 sc1
    s_add_u32 s70, s70, 3072
    buffer_load_dwordx4 v[40:43], v2, s[64:67], s70 offen offset:0 sc1
    buffer_load_dwordx4 v[44:47], v2, s[64:67], s70 offen offset:1024 sc1
    buffer_load_dwordx4 v[48:51], v2, s[64:67], s70 offen offset:2048 sc1
    s_add_u32 s70, s70, 3072
    buffer_load_dwordx4 v[52:55], v2, s[64:67], s70 offen offset:0 sc1
    buffer_load_dwordx4 v[56:59], v2, s[64:67], s70 offen offset:1024 sc1
    buffer_load_dwordx4 v[60:63], v2, s[64:67], s70 offen offset:2048 sc1
    s_add_u32 s70, s70, 3072
    buffer_load_dwordx4 v[64:67], v2, s[64:67], s70 offen offset:0 sc1
    buffer_load_dwordx4 v[68:71], v2, s[64:67], s70 offen offset:1024 sc1
    buffer_load_dwordx4 v[72:75], v2, s[64:67], s70 offen offset:2048 sc1
    s_add_u32 s70, s70, 3072
    buffer_load_dwordx4 v[76:79], v2, s[64:67], s70 offen offset:0 sc1
    buffer_load_dwordx4 v[80:83], v2, s[64:67], s70 offen offset:1024 sc1
    buffer_load_dwordx4 v[84:87], v2, s[64:67], s70 offen offset:2048 sc1
    s_add_u32 s70, s70, 3072
    buffer_load_dwordx4 v[88:91], v2, s[64:67], s70 offen offset:0 sc1
    buffer_load_dwordx4 v[92:95], v2, s[64:67], s70 offen offset:1024 sc1
    buffer_load_dwordx4 v[96:99], v2, s[64:67], s70 offen offset:2048 sc1
    s_add_u32 s70, s70, 3072
    v_add_u32 v3, 0, v2
    v_add_u32 v4, 36864, v2
    v_and_b32 v9, 15, v1
    v_lshlrev_b32 v9, 4, v9
    v_bfe_u32 v14, v1, 3, 1
    s_mov_b32 s46, 73728
    v_mul_lo_u32 v14, v14, s46
    v_lshl_add_u32 v14, v5, 4, v14
    v_and_b32 v15, 1, v6
    s_mov_b32 s46, 147456
    v_mul_lo_u32 v15, v15, s46
    v_add_u32 v15, v15, v14
    v_lshrrev_b32 v10, 1, v6
    v_lshl_add_u32 v15, v10, 7, v15
    v_lshl_add_u32 v14, v6, 7, v14
    s_lshl_b32 s46, s40, 8
    v_add_u32 v15, s46, v15
    s_lshl_b32 s46, s40, 9
    v_add_u32 v14, s46, v14
    s_lshl_b32 s71, s56, 6
    s_add_u32 s71, s71, s43
    s_mul_i32 s71, s71, 9216
    s_add_u32 s71, s71, 16908288
    s_mul_i32 s59, s40, 18432
    s_mul_i32 s53, s56, 73728
    s_lshl_b32 s47, s40, 10
    s_add_u32 s53, s53, s47
    s_add_u32 s53, s53, 3407872
    v_add_u32 v11, s47, v3
    v_add_u32 v12, s47, v4
    s_waitcnt vmcnt(18)
    s_add_u32 s46, s53, 0
    buffer_load_dwordx4 v[136:139], v2, s[32:35], s46 offen sc1
    s_add_u32 s46, s53, 4096
    buffer_load_dwordx4 v[140:143], v2, s[32:35], s46 offen sc1
    s_add_u32 s46, s53, 8192
    buffer_load_dwordx4 v[144:147], v2, s[32:35], s46 offen sc1
    s_add_u32 s46, s53, 12288
    buffer_load_dwordx4 v[148:151], v2, s[32:35], s46 offen sc1
    s_add_u32 s46, s53, 16384
    buffer_load_dwordx4 v[152:155], v2, s[32:35], s46 offen sc1
    s_add_u32 s46, s53, 20480
    buffer_load_dwordx4 v[156:159], v2, s[32:35], s46 offen sc1
    s_add_u32 s46, s53, 24576
    buffer_load_dwordx4 v[160:163], v2, s[32:35], s46 offen sc1
    s_add_u32 s46, s53, 28672
    buffer_load_dwordx4 v[164:167], v2, s[32:35], s46 offen sc1
    s_add_u32 s46, s53, 32768
    buffer_load_dwordx4 v[168:171], v2, s[32:35], s46 offen sc1
    s_add_u32 s46, s53, 36864
    buffer_load_dwordx4 v[172:175], v2, s[32:35], s46 offen sc1
    s_add_u32 s46, s53, 40960
    buffer_load_dwordx4 v[176:179], v2, s[32:35], s46 offen sc1
    s_add_u32 s46, s53, 45056
    buffer_load_dwordx4 v[180:183], v2, s[32:35], s46 offen sc1
    s_add_u32 s46, s53, 49152
    buffer_load_dwordx4 v[184:187], v2, s[32:35], s46 offen sc1
    s_add_u32 s46, s53, 53248
    buffer_load_dwordx4 v[188:191], v2, s[32:35], s46 offen sc1
    s_add_u32 s46, s53, 57344
    buffer_load_dwordx4 v[192:195], v2, s[32:35], s46 offen sc1
    s_add_u32 s46, s53, 61440
    buffer_load_dwordx4 v[196:199], v2, s[32:35], s46 offen sc1
    s_add_u32 s46, s53, 65536
    buffer_load_dwordx4 v[200:203], v2, s[32:35], s46 offen sc1
    s_add_u32 s46, s53, 69632
    buffer_load_dwordx4 v[204:207], v2, s[32:35], s46 offen sc1
    s_mov_b32 s49, 16384
    s_waitcnt vmcnt(12)
L_y_chk0:
    v_max3_u32 v13, v136, v137, v138
    v_max3_u32 v8, v139, v140, v141
    v_max3_u32 v13, v13, v142, v143
    v_max3_u32 v8, v8, v144, v145
    v_max3_u32 v13, v13, v146, v147
    v_max3_u32 v8, v8, v148, v149
    v_max3_u32 v13, v13, v150, v151
    v_max3_u32 v8, v8, v152, v153
    v_max3_u32 v13, v13, v154, v155
    v_max3_u32 v8, v8, v156, v157
    v_max3_u32 v13, v13, v158, v159
    v_max_u32 v13, v13, v8
    v_cmp_eq_u32 vcc, -1, v13
    s_sub_u32 s49, s49, 1
    s_cbranch_scc1 L_y_ok0
    s_cmp_eq_u64 vcc, 0
    s_cbranch_scc1 L_y_ok0
    s_sleep 2
    s_add_u32 s46, s53, 0
    buffer_load_dwordx4 v[136:139], v2, s[32:35], s46 offen sc1
    s_add_u32 s46, s53, 4096
    buffer_load_dwordx4 v[140:143], v2, s[32:35], s46 offen sc1
    s_add_u32 s46, s53, 8192
    buffer_load_dwordx4 v[144:147], v2, s[32:35], s46 offen sc1
    s_add_u32 s46, s53, 12288
    buffer_load_dwordx4 v[148:151], v2, s[32:35], s46 offen sc1
    s_add_u32 s46, s53, 16384
    buffer_load_dwordx4 v[152:155], v2, s[32:35], s46 offen sc1
    s_add_u32 s46, s53, 20480
    buffer_load_dwordx4 v[156:159], v2, s[32:35], s46 offen sc1
    s_add_u32 s46, s53, 24576
    buffer_load_dwordx4 v[160:163], v2, s[32:35], s46 offen sc1
    s_add_u32 s46, s53, 28672
    buffer_load_dwordx4 v[164:167], v2, s[32:35], s46 offen sc1
    s_add_u32 s46, s53, 32768
    buffer_load_dwordx4 v[168:171], v2, s[32:35], s46 offen sc1
    s_add_u32 s46, s53, 36864
    buffer_load_dwordx4 v[172:175], v2, s[32:35], s46 offen sc1
    s_add_u32 s46, s53, 40960
    buffer_load_dwordx4 v[176:179], v2, s[32:35], s46 offen sc1
    s_add_u32 s46, s53, 45056
    buffer_load_dwordx4 v[180:183], v2, s[32:35], s46 offen sc1
    s_add_u32 s46, s53, 49152
    buffer_load_dwordx4 v[184:187], v2, s[32:35], s46 offen sc1
    s_add_u32 s46, s53, 53248
    buffer_load_dwordx4 v[188:191], v2, s[32:35], s46 offen sc1
    s_add_u32 s46, s53, 57344
    buffer_load_dwordx4 v[192:195], v2, s[32:35], s46 offen sc1
    s_add_u32 s46, s53, 61440
    buffer_load_dwordx4 v[196:199], v2, s[32:35], s46 offen sc1
    s_add_u32 s46, s53, 65536
    buffer_load_dwordx4 v[200:203], v2, s[32:35], s46 offen sc1
    s_add_u32 s46, s53, 69632
    buffer_load_dwordx4 v[204:207], v2, s[32:35], s46 offen sc1
    s_waitcnt vmcnt(12)
    s_branch L_y_chk0
L_y_ok0:
    ds_write_b128 v11, v[136:139] offset:0
    ds_write_b128 v11, v[140:143] offset:4096
    ds_write_b128 v11, v[144:147] offset:8192
    ds_write_b128 v11, v[148:151] offset:12288
    ds_write_b128 v11, v[152:155] offset:16384
    ds_write_b128 v11, v[156:159] offset:20480
    s_waitcnt lgkmcnt(0)
    s_barrier
    s_mov_b32 s49, 16384
    s_waitcnt vmcnt(6)
L_y_chk1:
    v_max3_u32 v13, v160, v161, v162
    v_max3_u32 v8, v163, v164, v165
    v_max3_u32 v13, v13, v166, v167
    v_max3_u32 v8, v8, v168, v169
    v_max3_u32 v13, v13, v170, v171
    v_max3_u32 v8, v8, v172, v173
    v_max3_u32 v13, v13, v174, v175
    v_max3_u32 v8, v8, v176, v177
    v_max3_u32 v13, v13, v178, v179
    v_max3_u32 v8, v8, v180, v181
    v_max3_u32 v13, v13, v182, v183
    v_max_u32 v13, v13, v8
    v_cmp_eq_u32 vcc, -1, v13
    s_sub_u32 s49, s49, 1
    s_cbranch_scc1 L_y_ok1
    s_cmp_eq_u64 vcc, 0
    s_cbranch_scc1 L_y_ok1
    s_sleep 2
    s_add_u32 s46, s53, 24576
    buffer_load_dwordx4 v[160:163], v2, s[32:35], s46 offen sc1
    s_add_u32 s46, s53, 28672
    buffer_load_dwordx4 v[164:167], v2, s[32:35], s46 offen sc1
    s_add_u32 s46, s53, 32768
    buffer_load_dwordx4 v[168:171], v2, s[32:35], s46 offen sc1
    s_add_u32 s46, s53, 36864
    buffer_load_dwordx4 v[172:175], v2, s[32:35], s46 offen sc1
    s_add_u32 s46, s53, 40960
    buffer_load_dwordx4 v[176:179], v2, s[32:35], s46 offen sc1
    s_add_u32 s46, s53, 45056
    buffer_load_dwordx4 v[180:183], v2, s[32:35], s46 offen sc1
    s_add_u32 s46, s53, 49152
    buffer_load_dwordx4 v[184:187], v2, s[32:35], s46 offen sc1
    s_add_u32 s46, s53, 53248
    buffer_load_dwordx4 v[188:191], v2, s[32:35], s46 offen sc1
    s_add_u32 s46, s53, 57344
    buffer_load_dwordx4 v[192:195], v2, s[32:35], s46 offen sc1
    s_add_u32 s46, s53, 61440
    buffer_load_dwordx4 v[196:199], v2, s[32:35], s46 offen sc1
    s_add_u32 s46, s53, 65536
    buffer_load_dwordx4 v[200:203], v2, s[32:35], s46 offen sc1
    s_add_u32 s46, s53, 69632
    buffer_load_dwordx4 v[204:207], v2, s[32:35], s46 offen sc1
    s_waitcnt vmcnt(6)
    s_branch L_y_chk1
L_y_ok1:
    ds_write_b128 v11, v[160:163] offset:24576
    ds_write_b128 v11, v[164:167] offset:28672
    ds_write_b128 v11, v[168:171] offset:32768
    ds_write_b128 v12, v[172:175] offset:0
    ds_write_b128 v12, v[176:179] offset:4096
    ds_write_b128 v12, v[180:183] offset:8192
    s_waitcnt lgkmcnt(0)
    s_barrier
    s_mov_b32 s49, 16384
    s_waitcnt vmcnt(0)
L_y_chk2:
    v_max3_u32 v13, v184, v185, v186
    v_max3_u32 v8, v187, v188, v189
    v_max3_u32 v13, v13, v190, v191
    v_max3_u32 v8, v8, v192, v193
    v_max3_u32 v13, v13, v194, v195
    v_max3_u32 v8, v8, v196, v197
    v_max3_u32 v13, v13, v198, v199
    v_max3_u32 v8, v8, v200, v201
    v_max3_u32 v13, v13, v202, v203
    v_max3_u32 v8, v8, v204, v205
    v_max3_u32 v13, v13, v206, v207
    v_max_u32 v13, v13, v8
    v_cmp_eq_u32 vcc, -1, v13
    s_sub_u32 s49, s49, 1
    s_cbranch_scc1 L_y_ok2
    s_cmp_eq_u64 vcc, 0
    s_cbranch_scc1 L_y_ok2
    s_sleep 2
    s_add_u32 s46, s53, 49152
    buffer_load_dwordx4 v[184:187], v2, s[32:35], s46 offen sc1
    s_add_u32 s46, s53, 53248
    buffer_load_dwordx4 v[188:191], v2, s[32:35], s46 offen sc1
    s_add_u32 s46, s53, 57344
    buffer_load_dwordx4 v[192:195], v2, s[32:35], s46 offen sc1
    s_add_u32 s46, s53, 61440
    buffer_load_dwordx4 v[196:199], v2, s[32:35], s46 offen sc1
    s_add_u32 s46, s53, 65536
    buffer_load_dwordx4 v[200:203], v2, s[32:35], s46 offen sc1
    s_add_u32 s46, s53, 69632
    buffer_load_dwordx4 v[204:207], v2, s[32:35], s46 offen sc1
    s_waitcnt vmcnt(0)
    s_branch L_y_chk2
L_y_ok2:
    ds_write_b128 v12, v[184:187] offset:12288
    ds_write_b128 v12, v[188:191] offset:16384
    ds_write_b128 v12, v[192:195] offset:20480
    ds_write_b128 v12, v[196:199] offset:24576
    ds_write_b128 v12, v[200:203] offset:28672
    ds_write_b128 v12, v[204:207] offset:32768
    buffer_load_dwordx4 v[100:103], v2, s[64:67], s70 offen offset:0 sc1
    buffer_load_dwordx4 v[104:107], v2, s[64:67], s70 offen offset:1024 sc1
    buffer_load_dwordx4 v[108:111], v2, s[64:67], s70 offen offset:2048 sc1
    s_add_u32 s70, s70, 3072
    s_waitcnt lgkmcnt(0)
    s_barrier
    s_setprio 2
    s_mov_b32 s68, 1
    s_mul_i32 s46, s68, 768
    s_lshl_b32 s47, s40, 6
    s_add_u32 s46, s46, s47
    s_add_u32 s46, s46, 147456
    s_add_u32 s47, s46, s47
    v_lshl_add_u32 v11, v6, 5, s47
    v_lshl_add_u32 v12, v6, 4, s46
    ds_read_b128 v[16:19], v11 offset:2304
    ds_read_b128 v[20:23], v11 offset:2320
    ds_read_b128 v[24:27], v12 offset:512
    s_mov_b32 s69, 0
    s_call_b64 s[74:75], L_m_pass
    s_setprio 0
    s_call_b64 s[74:75], L_m_gelu
    v_add_u32 v7, s59, v2
    v_add_u32 v3, 73728, v3
    v_add_u32 v4, 73728, v4
    v_mov_b32 v16, 0
    v_mov_b32 v17, 0
    v_mov_b32 v18, 0
    v_mov_b32 v19, 0
    v_mov_b32 v20, 0
    v_mov_b32 v21, 0
    v_mov_b32 v22, 0
    v_mov_b32 v23, 0
    v_mov_b32 v24, 0
    v_mov_b32 v25, 0
    v_mov_b32 v26, 0
    v_mov_b32 v27, 0
    s_waitcnt lgkmcnt(0)
    s_barrier
    s_mov_b32 s69, 34
    s_call_b64 s[74:75], L_m_pass
    s_setprio 0
    s_mov_b32 s68, 0
    s_call_b64 s[74:75], L_m_cvt
    s_call_b64 s[74:75], L_m_st
    s_mov_b32 s36, s22
    s_and_b32 s37, s23, 0xffff
    s_mov_b32 s38, 1152
    s_mov_b32 s39, 0x00020000
    s_mov_b32 s24, s6
    s_and_b32 s25, s7, 0xffff
    s_mov_b32 s26, 2359296
    s_mov_b32 s27, 0x00020000
    s_mov_b32 s76, 0xffff0000
    s_mov_b32 s77, 0x40088e99
    s_lshl_b32 s46, s57, 7
    s_add_u32 s53, s46, 892928
    v_lshlrev_b32 v8, 4, v5
    s_waitcnt vmcnt(0)
    v_mov_b32 v11, 163352
    v_mov_b32 v12, 1
    s_mov_b64 exec, 1
    ds_add_rtn_u32 v13, v11, v12
    s_mov_b64 exec, -1
    s_lshl_b32 s46, s56, 10
    s_lshl_b32 s47, s43, 4
    s_add_u32 s46, s46, s47
    s_add_u32 s46, s46, 892928
    v_lshlrev_b32 v11, 7, v1
    s_waitcnt lgkmcnt(0)
    v_readfirstlane_b32 s47, v13
    v_mov_b32 v12, s30
    s_cmp_lg_u32 s47, 3
    s_cbranch_scc1 L_pf_b
    s_mov_b64 exec, 0xff
    buffer_store_dword v12, v11, s[32:35], s46 offen sc1
    s_mov_b64 exec, -1
L_pf_b:
    s_setprio 1
    s_mov_b32 s69, 10
    s_mov_b32 s68, 2
    s_call_b64 s[74:75], L_m_pass
    s_setprio 3
    s_call_b64 s[74:75], L_m_cvt
    s_call_b64 s[74:75], L_m_st
    s_min_u32 s48, s40, 2
    s_add_u32 s48, s48, 6
    s_call_b64 s[74:75], L_r_init
    s_waitcnt vmcnt(1)
    v_mov_b32 v11, 163360
    v_mov_b32 v12, 1
    s_mov_b64 exec, 1
    ds_add_rtn_u32 v13, v11, v12
    s_mov_b64 exec, -1
    s_lshl_b32 s46, s56, 10
    s_lshl_b32 s47, s43, 4
    s_add_u32 s46, s46, s47
    s_add_u32 s46, s46, 958464
    v_lshlrev_b32 v11, 7, v1
    s_waitcnt lgkmcnt(0)
    v_readfirstlane_b32 s47, v13
    v_mov_b32 v12, s30
    s_cmp_lg_u32 s47, 3
    s_cbranch_scc1 L_pf_c
    s_mov_b64 exec, 0xff
    buffer_store_dword v12, v11, s[32:35], s46 offen sc1
    s_mov_b64 exec, -1
L_pf_c:
    s_cmp_eq_u32 s40, 3
    s_cbranch_scc1 L_m_done
    s_add_u32 s53, s53, 65536
    s_mov_b32 s52, -1
    s_mov_b32 s49, 16384
L_r_poll2:
    buffer_load_dword v13, v8, s[32:35], s53 offen sc1
    s_waitcnt vmcnt(0)
    v_cmp_ne_u32 vcc, s30, v13
    s_sub_u32 s49, s49, 1
    s_cbranch_scc1 L_r_poll2_ok
    s_nop 1
    s_cmp_eq_u64 vcc, 0
    s_cbranch_scc1 L_r_poll2_ok
    s_sleep 1
    s_branch L_r_poll2
L_r_poll2_ok:
    s_call_b64 s[74:75], L_r_item
L_m_done:
L_end:
    s_endpgm
.p2align 6
L_m_pass:
    ds_read_b128 v[184:187], v3 offset:0
    ds_read_b128 v[188:191], v3 offset:1024
    ds_read_b128 v[192:195], v3 offset:2048
    ds_read_b128 v[196:199], v3 offset:3072
    ds_read_b128 v[200:203], v3 offset:4096
    ds_read_b128 v[204:207], v3 offset:5120
    ds_read_b128 v[208:211], v3 offset:6144
    ds_read_b128 v[212:215], v3 offset:7168
L_m_pass_nb:
    s_waitcnt vmcnt(15) lgkmcnt(0)
    v_mfma_f32_16x16x32_bf16 v[136:139], v[28:31], v[184:187], v[16:19]
    ds_read_b128 v[216:219], v3 offset:8192
    v_mfma_f32_16x16x32_bf16 v[136:139], v[40:43], v[200:203], v[136:139]
    buffer_load_dwordx4 v[112:115], v2, s[64:67], s70 offen offset:0 sc1
    v_mfma_f32_16x16x32_bf16 v[140:143], v[40:43], v[204:207], v[16:19]
    ds_read_b128 v[220:223], v3 offset:9216
    v_mfma_f32_16x16x32_bf16 v[140:143], v[28:31], v[188:191], v[140:143]
    v_mfma_f32_16x16x32_bf16 v[144:147], v[28:31], v[192:195], v[16:19]
    ds_read_b128 v[224:227], v3 offset:10240
    v_mfma_f32_16x16x32_bf16 v[144:147], v[40:43], v[208:211], v[144:147]
    buffer_load_dwordx4 v[116:119], v2, s[64:67], s70 offen offset:1024 sc1
    v_mfma_f32_16x16x32_bf16 v[148:151], v[40:43], v[212:215], v[16:19]
    ds_read_b128 v[228:231], v3 offset:11264
    v_mfma_f32_16x16x32_bf16 v[148:151], v[28:31], v[196:199], v[148:151]
    v_mfma_f32_16x16x32_bf16 v[164:167], v[32:35], v[196:199], v[20:23]
    ds_read_b128 v[232:235], v3 offset:12288
    v_mfma_f32_16x16x32_bf16 v[164:167], v[44:47], v[212:215], v[164:167]
    buffer_load_dwordx4 v[120:123], v2, s[64:67], s70 offen offset:2048 sc1
    v_mfma_f32_16x16x32_bf16 v[160:163], v[44:47], v[208:211], v[20:23]
    ds_read_b128 v[236:239], v3 offset:13312
    v_mfma_f32_16x16x32_bf16 v[160:163], v[32:35], v[192:195], v[160:163]
    s_add_u32 s70, s70, 3072
    v_mfma_f32_16x16x32_bf16 v[156:159], v[32:35], v[188:191], v[20:23]
    ds_read_b128 v[240:243], v3 offset:14336
    v_mfma_f32_16x16x32_bf16 v[156:159], v[44:47], v[204:207], v[156:159]
    buffer_load_dwordx4 v[124:127], v2, s[64:67], s70 offen offset:0 sc1
    v_mfma_f32_16x16x32_bf16 v[152:155], v[44:47], v[200:203], v[20:23]
    ds_read_b128 v[244:247], v3 offset:15360
    v_mfma_f32_16x16x32_bf16 v[152:155], v[32:35], v[184:187], v[152:155]
    v_mfma_f32_16x16x32_bf16 v[168:171], v[36:39], v[184:187], v[24:27]
    v_mfma_f32_16x16x32_bf16 v[168:171], v[48:51], v[200:203], v[168:171]
    buffer_load_dwordx4 v[128:131], v2, s[64:67], s70 offen offset:1024 sc1
    v_mfma_f32_16x16x32_bf16 v[172:175], v[48:51], v[204:207], v[24:27]
    v_mfma_f32_16x16x32_bf16 v[172:175], v[36:39], v[188:191], v[172:175]
    v_mfma_f32_16x16x32_bf16 v[176:179], v[36:39], v[192:195], v[24:27]
    buffer_load_dwordx4 v[132:135], v2, s[64:67], s70 offen offset:2048 sc1
    v_mfma_f32_16x16x32_bf16 v[176:179], v[48:51], v[208:211], v[176:179]
    v_mfma_f32_16x16x32_bf16 v[180:183], v[48:51], v[212:215], v[24:27]
    s_add_u32 s70, s70, 3072
    v_mfma_f32_16x16x32_bf16 v[180:183], v[36:39], v[196:199], v[180:183]
    s_waitcnt vmcnt(15) lgkmcnt(0)
    v_mfma_f32_16x16x32_bf16 v[136:139], v[52:55], v[216:219], v[136:139]
    ds_read_b128 v[184:187], v3 offset:16384
    v_mfma_f32_16x16x32_bf16 v[136:139], v[64:67], v[232:235], v[136:139]
    buffer_load_dwordx4 v[28:31], v2, s[64:67], s70 offen offset:0 sc1
    v_mfma_f32_16x16x32_bf16 v[140:143], v[64:67], v[236:239], v[140:143]
    ds_read_b128 v[188:191], v3 offset:17408
    v_mfma_f32_16x16x32_bf16 v[140:143], v[52:55], v[220:223], v[140:143]
    v_mfma_f32_16x16x32_bf16 v[144:147], v[52:55], v[224:227], v[144:147]
    ds_read_b128 v[192:195], v3 offset:18432
    v_mfma_f32_16x16x32_bf16 v[144:147], v[64:67], v[240:243], v[144:147]
    buffer_load_dwordx4 v[32:35], v2, s[64:67], s70 offen offset:1024 sc1
    v_mfma_f32_16x16x32_bf16 v[148:151], v[64:67], v[244:247], v[148:151]
    ds_read_b128 v[196:199], v3 offset:19456
    v_mfma_f32_16x16x32_bf16 v[148:151], v[52:55], v[228:231], v[148:151]
    v_mfma_f32_16x16x32_bf16 v[164:167], v[56:59], v[228:231], v[164:167]
    ds_read_b128 v[200:203], v3 offset:20480
    v_mfma_f32_16x16x32_bf16 v[164:167], v[68:71], v[244:247], v[164:167]
    buffer_load_dwordx4 v[36:39], v2, s[64:67], s70 offen offset:2048 sc1
    v_mfma_f32_16x16x32_bf16 v[160:163], v[68:71], v[240:243], v[160:163]
    ds_read_b128 v[204:207], v3 offset:21504
    v_mfma_f32_16x16x32_bf16 v[160:163], v[56:59], v[224:227], v[160:163]
    s_add_u32 s70, s70, 3072
    v_mfma_f32_16x16x32_bf16 v[156:159], v[56:59], v[220:223], v[156:159]
    ds_read_b128 v[208:211], v3 offset:22528
    v_mfma_f32_16x16x32_bf16 v[156:159], v[68:71], v[236:239], v[156:159]
    buffer_load_dwordx4 v[40:43], v2, s[64:67], s70 offen offset:0 sc1
    v_mfma_f32_16x16x32_bf16 v[152:155], v[68:71], v[232:235], v[152:155]
    ds_read_b128 v[212:215], v3 offset:23552
    v_mfma_f32_16x16x32_bf16 v[152:155], v[56:59], v[216:219], v[152:155]
    v_mfma_f32_16x16x32_bf16 v[168:171], v[60:63], v[216:219], v[168:171]
    v_mfma_f32_16x16x32_bf16 v[168:171], v[72:75], v[232:235], v[168:171]
    buffer_load_dwordx4 v[44:47], v2, s[64:67], s70 offen offset:1024 sc1
    v_mfma_f32_16x16x32_bf16 v[172:175], v[72:75], v[236:239], v[172:175]
    v_mfma_f32_16x16x32_bf16 v[172:175], v[60:63], v[220:223], v[172:175]
    v_mfma_f32_16x16x32_bf16 v[176:179], v[60:63], v[224:227], v[176:179]
    buffer_load_dwordx4 v[48:51], v2, s[64:67], s70 offen offset:2048 sc1
    v_mfma_f32_16x16x32_bf16 v[176:179], v[72:75], v[240:243], v[176:179]
    v_mfma_f32_16x16x32_bf16 v[180:183], v[72:75], v[244:247], v[180:183]
    s_add_u32 s70, s70, 3072
    v_mfma_f32_16x16x32_bf16 v[180:183], v[60:63], v[228:231], v[180:183]
L_m_pass_p2:
    s_bitcmp1_b32 s69, 0
    s_cbranch_scc0 L_m_nb4
    s_barrier
L_m_nb4:
    s_waitcnt vmcnt(15) lgkmcnt(0)
    v_mfma_f32_16x16x32_bf16 v[136:139], v[76:79], v[184:187], v[136:139]
    ds_read_b128 v[216:219], v3 offset:24576
    v_mfma_f32_16x16x32_bf16 v[136:139], v[88:91], v[200:203], v[136:139]
    buffer_load_dwordx4 v[52:55], v2, s[64:67], s70 offen offset:0 sc1
    v_mfma_f32_16x16x32_bf16 v[140:143], v[88:91], v[204:207], v[140:143]
    ds_read_b128 v[220:223], v3 offset:25600
    v_mfma_f32_16x16x32_bf16 v[140:143], v[76:79], v[188:191], v[140:143]
    v_mfma_f32_16x16x32_bf16 v[144:147], v[76:79], v[192:195], v[144:147]
    ds_read_b128 v[224:227], v3 offset:26624
    v_mfma_f32_16x16x32_bf16 v[144:147], v[88:91], v[208:211], v[144:147]
    buffer_load_dwordx4 v[56:59], v2, s[64:67], s70 offen offset:1024 sc1
    v_mfma_f32_16x16x32_bf16 v[148:151], v[88:91], v[212:215], v[148:151]
    ds_read_b128 v[228:231], v3 offset:27648
    v_mfma_f32_16x16x32_bf16 v[148:151], v[76:79], v[196:199], v[148:151]
    v_mfma_f32_16x16x32_bf16 v[164:167], v[80:83], v[196:199], v[164:167]
    ds_read_b128 v[232:235], v3 offset:28672
    v_mfma_f32_16x16x32_bf16 v[164:167], v[92:95], v[212:215], v[164:167]
    buffer_load_dwordx4 v[60:63], v2, s[64:67], s70 offen offset:2048 sc1
    v_mfma_f32_16x16x32_bf16 v[160:163], v[92:95], v[208:211], v[160:163]
    ds_read_b128 v[236:239], v3 offset:29696
    v_mfma_f32_16x16x32_bf16 v[160:163], v[80:83], v[192:195], v[160:163]
    s_add_u32 s70, s70, 3072
    v_mfma_f32_16x16x32_bf16 v[156:159], v[80:83], v[188:191], v[156:159]
    ds_read_b128 v[240:243], v3 offset:30720
    v_mfma_f32_16x16x32_bf16 v[156:159], v[92:95], v[204:207], v[156:159]
    buffer_load_dwordx4 v[64:67], v2, s[64:67], s70 offen offset:0 sc1
    v_mfma_f32_16x16x32_bf16 v[152:155], v[92:95], v[200:203], v[152:155]
    ds_read_b128 v[244:247], v3 offset:31744
    v_mfma_f32_16x16x32_bf16 v[152:155], v[80:83], v[184:187], v[152:155]
    v_mfma_f32_16x16x32_bf16 v[168:171], v[84:87], v[184:187], v[168:171]
    v_mfma_f32_16x16x32_bf16 v[168:171], v[96:99], v[200:203], v[168:171]
    buffer_load_dwordx4 v[68:71], v2, s[64:67], s70 offen offset:1024 sc1
    v_mfma_f32_16x16x32_bf16 v[172:175], v[96:99], v[204:207], v[172:175]
    v_mfma_f32_16x16x32_bf16 v[172:175], v[84:87], v[188:191], v[172:175]
    v_mfma_f32_16x16x32_bf16 v[176:179], v[84:87], v[192:195], v[176:179]
    buffer_load_dwordx4 v[72:75], v2, s[64:67], s70 offen offset:2048 sc1
    v_mfma_f32_16x16x32_bf16 v[176:179], v[96:99], v[208:211], v[176:179]
    v_mfma_f32_16x16x32_bf16 v[180:183], v[96:99], v[212:215], v[180:183]
    s_add_u32 s70, s70, 3072
    v_mfma_f32_16x16x32_bf16 v[180:183], v[84:87], v[196:199], v[180:183]
L_m_pass_p3:
    s_waitcnt vmcnt(15) lgkmcnt(0)
    v_mfma_f32_16x16x32_bf16 v[136:139], v[100:103], v[216:219], v[136:139]
    ds_read_b128 v[184:187], v3 offset:32768
    v_mfma_f32_16x16x32_bf16 v[136:139], v[112:115], v[232:235], v[136:139]
    buffer_load_dwordx4 v[76:79], v2, s[64:67], s70 offen offset:0 sc1
    v_mfma_f32_16x16x32_bf16 v[140:143], v[112:115], v[236:239], v[140:143]
    ds_read_b128 v[188:191], v3 offset:33792
    v_mfma_f32_16x16x32_bf16 v[140:143], v[100:103], v[220:223], v[140:143]
    v_mfma_f32_16x16x32_bf16 v[144:147], v[100:103], v[224:227], v[144:147]
    ds_read_b128 v[192:195], v3 offset:34816
    v_mfma_f32_16x16x32_bf16 v[144:147], v[112:115], v[240:243], v[144:147]
    buffer_load_dwordx4 v[80:83], v2, s[64:67], s70 offen offset:1024 sc1
    v_mfma_f32_16x16x32_bf16 v[148:151], v[112:115], v[244:247], v[148:151]
    ds_read_b128 v[196:199], v3 offset:35840
    v_mfma_f32_16x16x32_bf16 v[148:151], v[100:103], v[228:231], v[148:151]
    v_mfma_f32_16x16x32_bf16 v[164:167], v[104:107], v[228:231], v[164:167]
    ds_read_b128 v[200:203], v4 offset:0
    v_mfma_f32_16x16x32_bf16 v[164:167], v[116:119], v[244:247], v[164:167]
    buffer_load_dwordx4 v[84:87], v2, s[64:67], s70 offen offset:2048 sc1
    v_mfma_f32_16x16x32_bf16 v[160:163], v[116:119], v[240:243], v[160:163]
    ds_read_b128 v[204:207], v4 offset:1024
    v_mfma_f32_16x16x32_bf16 v[160:163], v[104:107], v[224:227], v[160:163]
    s_add_u32 s70, s70, 3072
    v_mfma_f32_16x16x32_bf16 v[156:159], v[104:107], v[220:223], v[156:159]
    ds_read_b128 v[208:211], v4 offset:2048
    v_mfma_f32_16x16x32_bf16 v[156:159], v[116:119], v[236:239], v[156:159]
    buffer_load_dwordx4 v[88:91], v2, s[64:67], s70 offen offset:0 sc1
    v_mfma_f32_16x16x32_bf16 v[152:155], v[116:119], v[232:235], v[152:155]
    ds_read_b128 v[212:215], v4 offset:3072
    v_mfma_f32_16x16x32_bf16 v[152:155], v[104:107], v[216:219], v[152:155]
    v_mfma_f32_16x16x32_bf16 v[168:171], v[108:111], v[216:219], v[168:171]
    v_mfma_f32_16x16x32_bf16 v[168:171], v[120:123], v[232:235], v[168:171]
    buffer_load_dwordx4 v[92:95], v2, s[64:67], s70 offen offset:1024 sc1
    v_mfma_f32_16x16x32_bf16 v[172:175], v[120:123], v[236:239], v[172:175]
    v_mfma_f32_16x16x32_bf16 v[172:175], v[108:111], v[220:223], v[172:175]
    v_mfma_f32_16x16x32_bf16 v[176:179], v[108:111], v[224:227], v[176:179]
    buffer_load_dwordx4 v[96:99], v2, s[64:67], s70 offen offset:2048 sc1
    v_mfma_f32_16x16x32_bf16 v[176:179], v[120:123], v[240:243], v[176:179]
    v_mfma_f32_16x16x32_bf16 v[180:183], v[120:123], v[244:247], v[180:183]
    s_add_u32 s70, s70, 3072
    v_mfma_f32_16x16x32_bf16 v[180:183], v[108:111], v[228:231], v[180:183]
    s_waitcnt vmcnt(15) lgkmcnt(0)
    v_mfma_f32_16x16x32_bf16 v[136:139], v[124:127], v[184:187], v[136:139]
    ds_read_b128 v[216:219], v4 offset:4096
    v_mfma_f32_16x16x32_bf16 v[136:139], v[28:31], v[200:203], v[136:139]
    buffer_load_dwordx4 v[100:103], v2, s[64:67], s70 offen offset:0 sc1
    v_mfma_f32_16x16x32_bf16 v[140:143], v[28:31], v[204:207], v[140:143]
    ds_read_b128 v[220:223], v4 offset:5120
    v_mfma_f32_16x16x32_bf16 v[140:143], v[124:127], v[188:191], v[140:143]
    v_mfma_f32_16x16x32_bf16 v[144:147], v[124:127], v[192:195], v[144:147]
    ds_read_b128 v[224:227], v4 offset:6144
    v_mfma_f32_16x16x32_bf16 v[144:147], v[28:31], v[208:211], v[144:147]
    buffer_load_dwordx4 v[104:107], v2, s[64:67], s70 offen offset:1024 sc1
    v_mfma_f32_16x16x32_bf16 v[148:151], v[28:31], v[212:215], v[148:151]
    ds_read_b128 v[228:231], v4 offset:7168
    v_mfma_f32_16x16x32_bf16 v[148:151], v[124:127], v[196:199], v[148:151]
    v_mfma_f32_16x16x32_bf16 v[164:167], v[128:131], v[196:199], v[164:167]
    ds_read_b128 v[232:235], v4 offset:8192
    v_mfma_f32_16x16x32_bf16 v[164:167], v[32:35], v[212:215], v[164:167]
    buffer_load_dwordx4 v[108:111], v2, s[64:67], s70 offen offset:2048 sc1
    v_mfma_f32_16x16x32_bf16 v[160:163], v[32:35], v[208:211], v[160:163]
    ds_read_b128 v[236:239], v4 offset:9216
    v_mfma_f32_16x16x32_bf16 v[160:163], v[128:131], v[192:195], v[160:163]
    s_add_u32 s70, s70, 3072
    v_mfma_f32_16x16x32_bf16 v[156:159], v[128:131], v[188:191], v[156:159]
    ds_read_b128 v[240:243], v4 offset:10240
    v_mfma_f32_16x16x32_bf16 v[156:159], v[32:35], v[204:207], v[156:159]
    buffer_load_dwordx4 v[112:115], v2, s[64:67], s70 offen offset:0 sc1
    v_mfma_f32_16x16x32_bf16 v[152:155], v[32:35], v[200:203], v[152:155]
    ds_read_b128 v[244:247], v4 offset:11264
    v_mfma_f32_16x16x32_bf16 v[152:155], v[128:131], v[184:187], v[152:155]
    v_mfma_f32_16x16x32_bf16 v[168:171], v[132:135], v[184:187], v[168:171]
    v_mfma_f32_16x16x32_bf16 v[168:171], v[36:39], v[200:203], v[168:171]
    buffer_load_dwordx4 v[116:119], v2, s[64:67], s70 offen offset:1024 sc1
    v_mfma_f32_16x16x32_bf16 v[172:175], v[36:39], v[204:207], v[172:175]
    v_mfma_f32_16x16x32_bf16 v[172:175], v[132:135], v[188:191], v[172:175]
    v_mfma_f32_16x16x32_bf16 v[176:179], v[132:135], v[192:195], v[176:179]
    buffer_load_dwordx4 v[120:123], v2, s[64:67], s70 offen offset:2048 sc1
    v_mfma_f32_16x16x32_bf16 v[176:179], v[36:39], v[208:211], v[176:179]
    v_mfma_f32_16x16x32_bf16 v[180:183], v[36:39], v[212:215], v[180:183]
    s_add_u32 s70, s70, 3072
    v_mfma_f32_16x16x32_bf16 v[180:183], v[132:135], v[196:199], v[180:183]
    s_bitcmp1_b32 s69, 1
    s_cbranch_scc0 L_m_nb10
    s_barrier
    s_setprio 3
L_m_nb10:
    s_bitcmp1_b32 s69, 3
    s_cbranch_scc1 L_m_tail
    s_waitcnt vmcnt(15) lgkmcnt(0)
    v_mfma_f32_16x16x32_bf16 v[136:139], v[40:43], v[216:219], v[136:139]
    ds_read_b128 v[184:187], v4 offset:12288
    v_mfma_f32_16x16x32_bf16 v[136:139], v[52:55], v[232:235], v[136:139]
    buffer_load_dwordx4 v[124:127], v2, s[64:67], s70 offen offset:0 sc1
    v_mfma_f32_16x16x32_bf16 v[140:143], v[52:55], v[236:239], v[140:143]
    ds_read_b128 v[188:191], v4 offset:13312
    v_mfma_f32_16x16x32_bf16 v[140:143], v[40:43], v[220:223], v[140:143]
    v_mfma_f32_16x16x32_bf16 v[144:147], v[40:43], v[224:227], v[144:147]
    ds_read_b128 v[192:195], v4 offset:14336
    v_mfma_f32_16x16x32_bf16 v[144:147], v[52:55], v[240:243], v[144:147]
    buffer_load_dwordx4 v[128:131], v2, s[64:67], s70 offen offset:1024 sc1
    v_mfma_f32_16x16x32_bf16 v[148:151], v[52:55], v[244:247], v[148:151]
    ds_read_b128 v[196:199], v4 offset:15360
    v_mfma_f32_16x16x32_bf16 v[148:151], v[40:43], v[228:231], v[148:151]
    v_mfma_f32_16x16x32_bf16 v[164:167], v[44:47], v[228:231], v[164:167]
    ds_read_b128 v[200:203], v4 offset:16384
    v_mfma_f32_16x16x32_bf16 v[164:167], v[56:59], v[244:247], v[164:167]
    buffer_load_dwordx4 v[132:135], v2, s[64:67], s70 offen offset:2048 sc1
    v_mfma_f32_16x16x32_bf16 v[160:163], v[56:59], v[240:243], v[160:163]
    ds_read_b128 v[204:207], v4 offset:17408
    v_mfma_f32_16x16x32_bf16 v[160:163], v[44:47], v[224:227], v[160:163]
    s_add_u32 s70, s70, 3072
    v_mfma_f32_16x16x32_bf16 v[156:159], v[44:47], v[220:223], v[156:159]
    ds_read_b128 v[208:211], v4 offset:18432
    v_mfma_f32_16x16x32_bf16 v[156:159], v[56:59], v[236:239], v[156:159]
    buffer_load_dwordx4 v[28:31], v2, s[64:67], s70 offen offset:0 sc1
    v_mfma_f32_16x16x32_bf16 v[152:155], v[56:59], v[232:235], v[152:155]
    ds_read_b128 v[212:215], v4 offset:19456
    v_mfma_f32_16x16x32_bf16 v[152:155], v[44:47], v[216:219], v[152:155]
    v_mfma_f32_16x16x32_bf16 v[168:171], v[48:51], v[216:219], v[168:171]
    v_mfma_f32_16x16x32_bf16 v[168:171], v[60:63], v[232:235], v[168:171]
    buffer_load_dwordx4 v[32:35], v2, s[64:67], s70 offen offset:1024 sc1
    v_mfma_f32_16x16x32_bf16 v[172:175], v[60:63], v[236:239], v[172:175]
    v_mfma_f32_16x16x32_bf16 v[172:175], v[48:51], v[220:223], v[172:175]
    v_mfma_f32_16x16x32_bf16 v[176:179], v[48:51], v[224:227], v[176:179]
    buffer_load_dwordx4 v[36:39], v2, s[64:67], s70 offen offset:2048 sc1
    v_mfma_f32_16x16x32_bf16 v[176:179], v[60:63], v[240:243], v[176:179]
    v_mfma_f32_16x16x32_bf16 v[180:183], v[60:63], v[244:247], v[180:183]
    s_add_u32 s70, s70, 3072
    v_mfma_f32_16x16x32_bf16 v[180:183], v[48:51], v[228:231], v[180:183]
    s_waitcnt vmcnt(15) lgkmcnt(0)
    v_mfma_f32_16x16x32_bf16 v[136:139], v[64:67], v[184:187], v[136:139]
    ds_read_b128 v[216:219], v4 offset:20480
    v_mfma_f32_16x16x32_bf16 v[136:139], v[76:79], v[200:203], v[136:139]
    buffer_load_dwordx4 v[40:43], v2, s[64:67], s70 offen offset:0 sc1
    v_mfma_f32_16x16x32_bf16 v[140:143], v[76:79], v[204:207], v[140:143]
    ds_read_b128 v[220:223], v4 offset:21504
    v_mfma_f32_16x16x32_bf16 v[140:143], v[64:67], v[188:191], v[140:143]
    v_mfma_f32_16x16x32_bf16 v[144:147], v[64:67], v[192:195], v[144:147]
    ds_read_b128 v[224:227], v4 offset:22528
    v_mfma_f32_16x16x32_bf16 v[144:147], v[76:79], v[208:211], v[144:147]
    buffer_load_dwordx4 v[44:47], v2, s[64:67], s70 offen offset:1024 sc1
    v_mfma_f32_16x16x32_bf16 v[148:151], v[76:79], v[212:215], v[148:151]
    ds_read_b128 v[228:231], v4 offset:23552
    v_mfma_f32_16x16x32_bf16 v[148:151], v[64:67], v[196:199], v[148:151]
    v_mfma_f32_16x16x32_bf16 v[164:167], v[68:71], v[196:199], v[164:167]
    ds_read_b128 v[232:235], v4 offset:24576
    v_mfma_f32_16x16x32_bf16 v[164:167], v[80:83], v[212:215], v[164:167]
    buffer_load_dwordx4 v[48:51], v2, s[64:67], s70 offen offset:2048 sc1
    v_mfma_f32_16x16x32_bf16 v[160:163], v[80:83], v[208:211], v[160:163]
    ds_read_b128 v[236:239], v4 offset:25600
    v_mfma_f32_16x16x32_bf16 v[160:163], v[68:71], v[192:195], v[160:163]
    s_add_u32 s70, s70, 3072
    v_mfma_f32_16x16x32_bf16 v[156:159], v[68:71], v[188:191], v[156:159]
    ds_read_b128 v[240:243], v4 offset:26624
    v_mfma_f32_16x16x32_bf16 v[156:159], v[80:83], v[204:207], v[156:159]
    buffer_load_dwordx4 v[52:55], v2, s[64:67], s70 offen offset:0 sc1
    v_mfma_f32_16x16x32_bf16 v[152:155], v[80:83], v[200:203], v[152:155]
    ds_read_b128 v[244:247], v4 offset:27648
    v_mfma_f32_16x16x32_bf16 v[152:155], v[68:71], v[184:187], v[152:155]
    v_mfma_f32_16x16x32_bf16 v[168:171], v[72:75], v[184:187], v[168:171]
    v_mfma_f32_16x16x32_bf16 v[168:171], v[84:87], v[200:203], v[168:171]
    buffer_load_dwordx4 v[56:59], v2, s[64:67], s70 offen offset:1024 sc1
    v_mfma_f32_16x16x32_bf16 v[172:175], v[84:87], v[204:207], v[172:175]
    v_mfma_f32_16x16x32_bf16 v[172:175], v[72:75], v[188:191], v[172:175]
    v_mfma_f32_16x16x32_bf16 v[176:179], v[72:75], v[192:195], v[176:179]
    buffer_load_dwordx4 v[60:63], v2, s[64:67], s70 offen offset:2048 sc1
    v_mfma_f32_16x16x32_bf16 v[176:179], v[84:87], v[208:211], v[176:179]
    v_mfma_f32_16x16x32_bf16 v[180:183], v[84:87], v[212:215], v[180:183]
    s_add_u32 s70, s70, 3072
    v_mfma_f32_16x16x32_bf16 v[180:183], v[72:75], v[196:199], v[180:183]
    s_bitcmp1_b32 s69, 5
    s_cbranch_scc0 L_m_nb14
    s_barrier
L_m_nb14:
    s_waitcnt vmcnt(15) lgkmcnt(0)
    v_mfma_f32_16x16x32_bf16 v[136:139], v[88:91], v[216:219], v[136:139]
    ds_read_b128 v[184:187], v4 offset:28672
    v_mfma_f32_16x16x32_bf16 v[136:139], v[100:103], v[232:235], v[136:139]
    buffer_load_dwordx4 v[64:67], v2, s[64:67], s70 offen offset:0 sc1
    v_mfma_f32_16x16x32_bf16 v[140:143], v[100:103], v[236:239], v[140:143]
    ds_read_b128 v[188:191], v4 offset:29696
    v_mfma_f32_16x16x32_bf16 v[140:143], v[88:91], v[220:223], v[140:143]
    v_mfma_f32_16x16x32_bf16 v[144:147], v[88:91], v[224:227], v[144:147]
    ds_read_b128 v[192:195], v4 offset:30720
    v_mfma_f32_16x16x32_bf16 v[144:147], v[100:103], v[240:243], v[144:147]
    buffer_load_dwordx4 v[68:71], v2, s[64:67], s70 offen offset:1024 sc1
    v_mfma_f32_16x16x32_bf16 v[148:151], v[100:103], v[244:247], v[148:151]
    ds_read_b128 v[196:199], v4 offset:31744
    v_mfma_f32_16x16x32_bf16 v[148:151], v[88:91], v[228:231], v[148:151]
    v_mfma_f32_16x16x32_bf16 v[164:167], v[92:95], v[228:231], v[164:167]
    ds_read_b128 v[200:203], v4 offset:32768
    v_mfma_f32_16x16x32_bf16 v[164:167], v[104:107], v[244:247], v[164:167]
    buffer_load_dwordx4 v[72:75], v2, s[64:67], s70 offen offset:2048 sc1
    v_mfma_f32_16x16x32_bf16 v[160:163], v[104:107], v[240:243], v[160:163]
    ds_read_b128 v[204:207], v4 offset:33792
    v_mfma_f32_16x16x32_bf16 v[160:163], v[92:95], v[224:227], v[160:163]
    s_add_u32 s70, s70, 3072
    v_mfma_f32_16x16x32_bf16 v[156:159], v[92:95], v[220:223], v[156:159]
    ds_read_b128 v[208:211], v4 offset:34816
    v_mfma_f32_16x16x32_bf16 v[156:159], v[104:107], v[236:239], v[156:159]
    buffer_load_dwordx4 v[76:79], v2, s[64:67], s70 offen offset:0 sc1
    v_mfma_f32_16x16x32_bf16 v[152:155], v[104:107], v[232:235], v[152:155]
    ds_read_b128 v[212:215], v4 offset:35840
    v_mfma_f32_16x16x32_bf16 v[152:155], v[92:95], v[216:219], v[152:155]
    v_mfma_f32_16x16x32_bf16 v[168:171], v[96:99], v[216:219], v[168:171]
    v_mfma_f32_16x16x32_bf16 v[168:171], v[108:111], v[232:235], v[168:171]
    buffer_load_dwordx4 v[80:83], v2, s[64:67], s70 offen offset:1024 sc1
    v_mfma_f32_16x16x32_bf16 v[172:175], v[108:111], v[236:239], v[172:175]
    v_mfma_f32_16x16x32_bf16 v[172:175], v[96:99], v[220:223], v[172:175]
    v_mfma_f32_16x16x32_bf16 v[176:179], v[96:99], v[224:227], v[176:179]
    buffer_load_dwordx4 v[84:87], v2, s[64:67], s70 offen offset:2048 sc1
    v_mfma_f32_16x16x32_bf16 v[176:179], v[108:111], v[240:243], v[176:179]
    v_mfma_f32_16x16x32_bf16 v[180:183], v[108:111], v[244:247], v[180:183]
    s_add_u32 s70, s70, 3072
    v_mfma_f32_16x16x32_bf16 v[180:183], v[96:99], v[228:231], v[180:183]
    s_waitcnt vmcnt(15) lgkmcnt(0)
    v_mfma_f32_16x16x32_bf16 v[136:139], v[112:115], v[184:187], v[136:139]
    v_mfma_f32_16x16x32_bf16 v[136:139], v[124:127], v[200:203], v[136:139]
    buffer_load_dwordx4 v[88:91], v2, s[64:67], s70 offen offset:0 sc1
    v_mfma_f32_16x16x32_bf16 v[140:143], v[124:127], v[204:207], v[140:143]
    v_mfma_f32_16x16x32_bf16 v[140:143], v[112:115], v[188:191], v[140:143]
    v_mfma_f32_16x16x32_bf16 v[144:147], v[112:115], v[192:195], v[144:147]
    v_mfma_f32_16x16x32_bf16 v[144:147], v[124:127], v[208:211], v[144:147]
    buffer_load_dwordx4 v[92:95], v2, s[64:67], s70 offen offset:1024 sc1
    v_mfma_f32_16x16x32_bf16 v[148:151], v[124:127], v[212:215], v[148:151]
    v_mfma_f32_16x16x32_bf16 v[148:151], v[112:115], v[196:199], v[148:151]
    v_mfma_f32_16x16x32_bf16 v[164:167], v[116:119], v[196:199], v[164:167]
    v_mfma_f32_16x16x32_bf16 v[164:167], v[128:131], v[212:215], v[164:167]
    buffer_load_dwordx4 v[96:99], v2, s[64:67], s70 offen offset:2048 sc1
    v_mfma_f32_16x16x32_bf16 v[160:163], v[128:131], v[208:211], v[160:163]
    v_mfma_f32_16x16x32_bf16 v[160:163], v[116:119], v[192:195], v[160:163]
    s_add_u32 s70, s70, 3072
    v_mfma_f32_16x16x32_bf16 v[156:159], v[116:119], v[188:191], v[156:159]
    v_mfma_f32_16x16x32_bf16 v[156:159], v[128:131], v[204:207], v[156:159]
    buffer_load_dwordx4 v[100:103], v2, s[64:67], s70 offen offset:0 sc1
    v_mfma_f32_16x16x32_bf16 v[152:155], v[128:131], v[200:203], v[152:155]
    v_mfma_f32_16x16x32_bf16 v[152:155], v[116:119], v[184:187], v[152:155]
    v_mfma_f32_16x16x32_bf16 v[168:171], v[120:123], v[184:187], v[168:171]
    v_mfma_f32_16x16x32_bf16 v[168:171], v[132:135], v[200:203], v[168:171]
    buffer_load_dwordx4 v[104:107], v2, s[64:67], s70 offen offset:1024 sc1
    v_mfma_f32_16x16x32_bf16 v[172:175], v[132:135], v[204:207], v[172:175]
    v_mfma_f32_16x16x32_bf16 v[172:175], v[120:123], v[188:191], v[172:175]
    v_mfma_f32_16x16x32_bf16 v[176:179], v[120:123], v[192:195], v[176:179]
    buffer_load_dwordx4 v[108:111], v2, s[64:67], s70 offen offset:2048 sc1
    v_mfma_f32_16x16x32_bf16 v[176:179], v[132:135], v[208:211], v[176:179]
    v_mfma_f32_16x16x32_bf16 v[180:183], v[132:135], v[212:215], v[180:183]
    s_add_u32 s70, s70, 3072
    v_mfma_f32_16x16x32_bf16 v[180:183], v[120:123], v[196:199], v[180:183]
    s_nop 7
    s_setpc_b64 s[74:75]
L_m_tail:
    s_waitcnt vmcnt(15) lgkmcnt(0)
    v_mfma_f32_16x16x32_bf16 v[136:139], v[40:43], v[216:219], v[136:139]
    ds_read_b128 v[184:187], v4 offset:12288
    v_mfma_f32_16x16x32_bf16 v[136:139], v[52:55], v[232:235], v[136:139]
    buffer_load_dwordx4 v[124:127], v2, s[64:67], s70 offen offset:0 sc1
    v_mfma_f32_16x16x32_bf16 v[140:143], v[52:55], v[236:239], v[140:143]
    ds_read_b128 v[188:191], v4 offset:13312
    v_mfma_f32_16x16x32_bf16 v[140:143], v[40:43], v[220:223], v[140:143]
    v_mfma_f32_16x16x32_bf16 v[144:147], v[40:43], v[224:227], v[144:147]
    ds_read_b128 v[192:195], v4 offset:14336
    v_mfma_f32_16x16x32_bf16 v[144:147], v[52:55], v[240:243], v[144:147]
    buffer_load_dwordx4 v[128:131], v2, s[64:67], s70 offen offset:1024 sc1
    v_mfma_f32_16x16x32_bf16 v[148:151], v[52:55], v[244:247], v[148:151]
    ds_read_b128 v[196:199], v4 offset:15360
    v_mfma_f32_16x16x32_bf16 v[148:151], v[40:43], v[228:231], v[148:151]
    v_mfma_f32_16x16x32_bf16 v[164:167], v[44:47], v[228:231], v[164:167]
    ds_read_b128 v[200:203], v4 offset:16384
    v_mfma_f32_16x16x32_bf16 v[164:167], v[56:59], v[244:247], v[164:167]
    buffer_load_dwordx4 v[132:135], v2, s[64:67], s70 offen offset:2048 sc1
    v_mfma_f32_16x16x32_bf16 v[160:163], v[56:59], v[240:243], v[160:163]
    ds_read_b128 v[204:207], v4 offset:17408
    v_mfma_f32_16x16x32_bf16 v[160:163], v[44:47], v[224:227], v[160:163]
    s_add_u32 s70, s70, 3072
    v_mfma_f32_16x16x32_bf16 v[156:159], v[44:47], v[220:223], v[156:159]
    ds_read_b128 v[208:211], v4 offset:18432
    v_mfma_f32_16x16x32_bf16 v[156:159], v[56:59], v[236:239], v[156:159]
    v_mfma_f32_16x16x32_bf16 v[152:155], v[56:59], v[232:235], v[152:155]
    ds_read_b128 v[212:215], v4 offset:19456
    v_mfma_f32_16x16x32_bf16 v[152:155], v[44:47], v[216:219], v[152:155]
    v_mfma_f32_16x16x32_bf16 v[168:171], v[48:51], v[216:219], v[168:171]
    v_mfma_f32_16x16x32_bf16 v[168:171], v[60:63], v[232:235], v[168:171]
    v_mfma_f32_16x16x32_bf16 v[172:175], v[60:63], v[236:239], v[172:175]
    v_mfma_f32_16x16x32_bf16 v[172:175], v[48:51], v[220:223], v[172:175]
    v_mfma_f32_16x16x32_bf16 v[176:179], v[48:51], v[224:227], v[176:179]
    v_mfma_f32_16x16x32_bf16 v[176:179], v[60:63], v[240:243], v[176:179]
    v_mfma_f32_16x16x32_bf16 v[180:183], v[60:63], v[244:247], v[180:183]
    v_mfma_f32_16x16x32_bf16 v[180:183], v[48:51], v[228:231], v[180:183]
    s_waitcnt vmcnt(12) lgkmcnt(0)
    v_mfma_f32_16x16x32_bf16 v[136:139], v[64:67], v[184:187], v[136:139]
    ds_read_b128 v[216:219], v4 offset:20480
    v_mfma_f32_16x16x32_bf16 v[136:139], v[76:79], v[200:203], v[136:139]
    v_mfma_f32_16x16x32_bf16 v[140:143], v[76:79], v[204:207], v[140:143]
    ds_read_b128 v[220:223], v4 offset:21504
    v_mfma_f32_16x16x32_bf16 v[140:143], v[64:67], v[188:191], v[140:143]
    v_mfma_f32_16x16x32_bf16 v[144:147], v[64:67], v[192:195], v[144:147]
    ds_read_b128 v[224:227], v4 offset:22528
    v_mfma_f32_16x16x32_bf16 v[144:147], v[76:79], v[208:211], v[144:147]
    v_mfma_f32_16x16x32_bf16 v[148:151], v[76:79], v[212:215], v[148:151]
    ds_read_b128 v[228:231], v4 offset:23552
    v_mfma_f32_16x16x32_bf16 v[148:151], v[64:67], v[196:199], v[148:151]
    v_mfma_f32_16x16x32_bf16 v[164:167], v[68:71], v[196:199], v[164:167]
    ds_read_b128 v[232:235], v4 offset:24576
    v_mfma_f32_16x16x32_bf16 v[164:167], v[80:83], v[212:215], v[164:167]
    v_mfma_f32_16x16x32_bf16 v[160:163], v[80:83], v[208:211], v[160:163]
    ds_read_b128 v[236:239], v4 offset:25600
    v_mfma_f32_16x16x32_bf16 v[160:163], v[68:71], v[192:195], v[160:163]
    v_mfma_f32_16x16x32_bf16 v[156:159], v[68:71], v[188:191], v[156:159]
    ds_read_b128 v[240:243], v4 offset:26624
    v_mfma_f32_16x16x32_bf16 v[156:159], v[80:83], v[204:207], v[156:159]
    v_mfma_f32_16x16x32_bf16 v[152:155], v[80:83], v[200:203], v[152:155]
    ds_read_b128 v[244:247], v4 offset:27648
    v_mfma_f32_16x16x32_bf16 v[152:155], v[68:71], v[184:187], v[152:155]
    v_mfma_f32_16x16x32_bf16 v[168:171], v[72:75], v[184:187], v[168:171]
    v_mfma_f32_16x16x32_bf16 v[168:171], v[84:87], v[200:203], v[168:171]
    v_mfma_f32_16x16x32_bf16 v[172:175], v[84:87], v[204:207], v[172:175]
    v_mfma_f32_16x16x32_bf16 v[172:175], v[72:75], v[188:191], v[172:175]
    v_mfma_f32_16x16x32_bf16 v[176:179], v[72:75], v[192:195], v[176:179]
    v_mfma_f32_16x16x32_bf16 v[176:179], v[84:87], v[208:211], v[176:179]
    v_mfma_f32_16x16x32_bf16 v[180:183], v[84:87], v[212:215], v[180:183]
    v_mfma_f32_16x16x32_bf16 v[180:183], v[72:75], v[196:199], v[180:183]
    s_waitcnt vmcnt(6) lgkmcnt(0)
    v_mfma_f32_16x16x32_bf16 v[136:139], v[88:91], v[216:219], v[136:139]
    ds_read_b128 v[184:187], v4 offset:28672
    v_mfma_f32_16x16x32_bf16 v[136:139], v[100:103], v[232:235], v[136:139]
    v_mfma_f32_16x16x32_bf16 v[140:143], v[100:103], v[236:239], v[140:143]
    ds_read_b128 v[188:191], v4 offset:29696
    v_mfma_f32_16x16x32_bf16 v[140:143], v[88:91], v[220:223], v[140:143]
    v_mfma_f32_16x16x32_bf16 v[144:147], v[88:91], v[224:227], v[144:147]
    ds_read_b128 v[192:195], v4 offset:30720
    v_mfma_f32_16x16x32_bf16 v[144:147], v[100:103], v[240:243], v[144:147]
    v_mfma_f32_16x16x32_bf16 v[148:151], v[100:103], v[244:247], v[148:151]
    ds_read_b128 v[196:199], v4 offset:31744
    v_mfma_f32_16x16x32_bf16 v[148:151], v[88:91], v[228:231], v[148:151]
    v_mfma_f32_16x16x32_bf16 v[164:167], v[92:95], v[228:231], v[164:167]
    ds_read_b128 v[200:203], v4 offset:32768
    v_mfma_f32_16x16x32_bf16 v[164:167], v[104:107], v[244:247], v[164:167]
    v_mfma_f32_16x16x32_bf16 v[160:163], v[104:107], v[240:243], v[160:163]
    ds_read_b128 v[204:207], v4 offset:33792
    v_mfma_f32_16x16x32_bf16 v[160:163], v[92:95], v[224:227], v[160:163]
    v_mfma_f32_16x16x32_bf16 v[156:159], v[92:95], v[220:223], v[156:159]
    ds_read_b128 v[208:211], v4 offset:34816
    v_mfma_f32_16x16x32_bf16 v[156:159], v[104:107], v[236:239], v[156:159]
    v_mfma_f32_16x16x32_bf16 v[152:155], v[104:107], v[232:235], v[152:155]
    ds_read_b128 v[212:215], v4 offset:35840
    v_mfma_f32_16x16x32_bf16 v[152:155], v[92:95], v[216:219], v[152:155]
    v_mfma_f32_16x16x32_bf16 v[168:171], v[96:99], v[216:219], v[168:171]
    v_mfma_f32_16x16x32_bf16 v[168:171], v[108:111], v[232:235], v[168:171]
    v_mfma_f32_16x16x32_bf16 v[172:175], v[108:111], v[236:239], v[172:175]
    v_mfma_f32_16x16x32_bf16 v[172:175], v[96:99], v[220:223], v[172:175]
    v_mfma_f32_16x16x32_bf16 v[176:179], v[96:99], v[224:227], v[176:179]
    v_mfma_f32_16x16x32_bf16 v[176:179], v[108:111], v[240:243], v[176:179]
    v_mfma_f32_16x16x32_bf16 v[180:183], v[108:111], v[244:247], v[180:183]
    v_mfma_f32_16x16x32_bf16 v[180:183], v[96:99], v[228:231], v[180:183]
    s_waitcnt vmcnt(0) lgkmcnt(0)
    v_mfma_f32_16x16x32_bf16 v[136:139], v[112:115], v[184:187], v[136:139]
    v_mfma_f32_16x16x32_bf16 v[136:139], v[124:127], v[200:203], v[136:139]
    v_mfma_f32_16x16x32_bf16 v[140:143], v[124:127], v[204:207], v[140:143]
    v_mfma_f32_16x16x32_bf16 v[140:143], v[112:115], v[188:191], v[140:143]
    v_mfma_f32_16x16x32_bf16 v[144:147], v[112:115], v[192:195], v[144:147]
    v_mfma_f32_16x16x32_bf16 v[144:147], v[124:127], v[208:211], v[144:147]
    v_mfma_f32_16x16x32_bf16 v[148:151], v[124:127], v[212:215], v[148:151]
    v_mfma_f32_16x16x32_bf16 v[148:151], v[112:115], v[196:199], v[148:151]
    v_mfma_f32_16x16x32_bf16 v[164:167], v[116:119], v[196:199], v[164:167]
    v_mfma_f32_16x16x32_bf16 v[164:167], v[128:131], v[212:215], v[164:167]
    v_mfma_f32_16x16x32_bf16 v[160:163], v[128:131], v[208:211], v[160:163]
    v_mfma_f32_16x16x32_bf16 v[160:163], v[116:119], v[192:195], v[160:163]
    v_mfma_f32_16x16x32_bf16 v[156:159], v[116:119], v[188:191], v[156:159]
    v_mfma_f32_16x16x32_bf16 v[156:159], v[128:131], v[204:207], v[156:159]
    v_mfma_f32_16x16x32_bf16 v[152:155], v[128:131], v[200:203], v[152:155]
    v_mfma_f32_16x16x32_bf16 v[152:155], v[116:119], v[184:187], v[152:155]
    v_mfma_f32_16x16x32_bf16 v[168:171], v[120:123], v[184:187], v[168:171]
    v_mfma_f32_16x16x32_bf16 v[168:171], v[132:135], v[200:203], v[168:171]
    v_mfma_f32_16x16x32_bf16 v[172:175], v[132:135], v[204:207], v[172:175]
    v_mfma_f32_16x16x32_bf16 v[172:175], v[120:123], v[188:191], v[172:175]
    v_mfma_f32_16x16x32_bf16 v[176:179], v[120:123], v[192:195], v[176:179]
    v_mfma_f32_16x16x32_bf16 v[176:179], v[132:135], v[208:211], v[176:179]
    v_mfma_f32_16x16x32_bf16 v[180:183], v[132:135], v[212:215], v[180:183]
    v_mfma_f32_16x16x32_bf16 v[180:183], v[120:123], v[196:199], v[180:183]
    s_nop 7
    s_setpc_b64 s[74:75]
L_m_gelu:
    s_mul_i32 s46, s68, 24576
    s_add_u32 s46, s46, 73728
    s_lshl_b32 s47, s40, 12
    s_add_u32 s47, s47, s46
    v_add_u32 v11, s47, v2
    v_fmaak_f32 v232, v136, v136, 0x409d30fc
    v_fmaak_f32 v233, v137, v137, 0x409d30fc
    v_fmaak_f32 v234, v138, v138, 0x409d30fc
    v_fmaak_f32 v235, v139, v139, 0x409d30fc
    v_fmaak_f32 v236, v140, v140, 0x409d30fc
    v_fmaak_f32 v237, v141, v141, 0x409d30fc
    v_fmaak_f32 v238, v142, v142, 0x409d30fc
    v_fmaak_f32 v239, v143, v143, 0x409d30fc
    v_mul_f32 v232, v136, v232
    v_mul_f32 v233, v137, v233
    v_mul_f32 v234, v138, v234
    v_mul_f32 v235, v139, v235
    v_mul_f32 v236, v140, v236
    v_mul_f32 v237, v141, v237
    v_mul_f32 v238, v142, v238
    v_mul_f32 v239, v143, v239
    v_exp_f32_e64 v232, -v232
    v_exp_f32_e64 v233, -v233
    v_exp_f32_e64 v234, -v234
    v_exp_f32_e64 v235, -v235
    v_exp_f32_e64 v236, -v236
    v_exp_f32_e64 v237, -v237
    v_exp_f32_e64 v238, -v238
    v_exp_f32_e64 v239, -v239
    v_add_f32 v232, 1.0, v232
    v_add_f32 v233, 1.0, v233
    v_add_f32 v234, 1.0, v234
    v_add_f32 v235, 1.0, v235
    v_add_f32 v236, 1.0, v236
    v_add_f32 v237, 1.0, v237
    v_add_f32 v238, 1.0, v238
    v_add_f32 v239, 1.0, v239
    v_rcp_f32 v232, v232
    v_rcp_f32 v233, v233
    v_rcp_f32 v234, v234
    v_rcp_f32 v235, v235
    v_rcp_f32 v236, v236
    v_rcp_f32 v237, v237
    v_rcp_f32 v238, v238
    v_rcp_f32 v239, v239
    v_mul_f32 v136, v136, v232
    v_mul_f32 v137, v137, v233
    v_mul_f32 v138, v138, v234
    v_mul_f32 v139, v139, v235
    v_mul_f32 v140, v140, v236
    v_mul_f32 v141, v141, v237
    v_mul_f32 v142, v142, v238
    v_mul_f32 v143, v143, v239
    v_fmaak_f32 v232, v152, v152, 0x409d30fc
    v_fmaak_f32 v233, v153, v153, 0x409d30fc
    v_fmaak_f32 v234, v154, v154, 0x409d30fc
    v_fmaak_f32 v235, v155, v155, 0x409d30fc
    v_fmaak_f32 v236, v156, v156, 0x409d30fc
    v_fmaak_f32 v237, v157, v157, 0x409d30fc
    v_fmaak_f32 v238, v158, v158, 0x409d30fc
    v_fmaak_f32 v239, v159, v159, 0x409d30fc
    v_mul_f32 v232, v152, v232
    v_mul_f32 v233, v153, v233
    v_mul_f32 v234, v154, v234
    v_mul_f32 v235, v155, v235
    v_mul_f32 v236, v156, v236
    v_mul_f32 v237, v157, v237
    v_mul_f32 v238, v158, v238
    v_mul_f32 v239, v159, v239
    v_exp_f32_e64 v232, -v232
    v_exp_f32_e64 v233, -v233
    v_exp_f32_e64 v234, -v234
    v_exp_f32_e64 v235, -v235
    v_exp_f32_e64 v236, -v236
    v_exp_f32_e64 v237, -v237
    v_exp_f32_e64 v238, -v238
    v_exp_f32_e64 v239, -v239
    v_add_f32 v232, 1.0, v232
    v_add_f32 v233, 1.0, v233
    v_add_f32 v234, 1.0, v234
    v_add_f32 v235, 1.0, v235
    v_add_f32 v236, 1.0, v236
    v_add_f32 v237, 1.0, v237
    v_add_f32 v238, 1.0, v238
    v_add_f32 v239, 1.0, v239
    v_rcp_f32 v232, v232
    v_rcp_f32 v233, v233
    v_rcp_f32 v234, v234
    v_rcp_f32 v235, v235
    v_rcp_f32 v236, v236
    v_rcp_f32 v237, v237
    v_rcp_f32 v238, v238
    v_rcp_f32 v239, v239
    v_mul_f32 v152, v152, v232
    v_mul_f32 v153, v153, v233
    v_mul_f32 v154, v154, v234
    v_mul_f32 v155, v155, v235
    v_mul_f32 v156, v156, v236
    v_mul_f32 v157, v157, v237
    v_mul_f32 v158, v158, v238
    v_mul_f32 v159, v159, v239
    v_cvt_pk_bf16_f32 v240, v136, v152
    v_cvt_pk_bf16_f32 v241, v137, v153
    v_cvt_pk_bf16_f32 v242, v138, v154
    v_cvt_pk_bf16_f32 v243, v139, v155
    ds_write_b128 v11, v[240:243] offset:0
    v_cvt_pk_bf16_f32 v244, v140, v156
    v_cvt_pk_bf16_f32 v245, v141, v157
    v_cvt_pk_bf16_f32 v246, v142, v158
    v_cvt_pk_bf16_f32 v247, v143, v159
    ds_write_b128 v11, v[244:247] offset:1024
    v_fmaak_f32 v232, v144, v144, 0x409d30fc
    v_fmaak_f32 v233, v145, v145, 0x409d30fc
    v_fmaak_f32 v234, v146, v146, 0x409d30fc
    v_fmaak_f32 v235, v147, v147, 0x409d30fc
    v_fmaak_f32 v236, v148, v148, 0x409d30fc
    v_fmaak_f32 v237, v149, v149, 0x409d30fc
    v_fmaak_f32 v238, v150, v150, 0x409d30fc
    v_fmaak_f32 v239, v151, v151, 0x409d30fc
    v_mul_f32 v232, v144, v232
    v_mul_f32 v233, v145, v233
    v_mul_f32 v234, v146, v234
    v_mul_f32 v235, v147, v235
    v_mul_f32 v236, v148, v236
    v_mul_f32 v237, v149, v237
    v_mul_f32 v238, v150, v238
    v_mul_f32 v239, v151, v239
    v_exp_f32_e64 v232, -v232
    v_exp_f32_e64 v233, -v233
    v_exp_f32_e64 v234, -v234
    v_exp_f32_e64 v235, -v235
    v_exp_f32_e64 v236, -v236
    v_exp_f32_e64 v237, -v237
    v_exp_f32_e64 v238, -v238
    v_exp_f32_e64 v239, -v239
    v_add_f32 v232, 1.0, v232
    v_add_f32 v233, 1.0, v233
    v_add_f32 v234, 1.0, v234
    v_add_f32 v235, 1.0, v235
    v_add_f32 v236, 1.0, v236
    v_add_f32 v237, 1.0, v237
    v_add_f32 v238, 1.0, v238
    v_add_f32 v239, 1.0, v239
    v_rcp_f32 v232, v232
    v_rcp_f32 v233, v233
    v_rcp_f32 v234, v234
    v_rcp_f32 v235, v235
    v_rcp_f32 v236, v236
    v_rcp_f32 v237, v237
    v_rcp_f32 v238, v238
    v_rcp_f32 v239, v239
    v_mul_f32 v144, v144, v232
    v_mul_f32 v145, v145, v233
    v_mul_f32 v146, v146, v234
    v_mul_f32 v147, v147, v235
    v_mul_f32 v148, v148, v236
    v_mul_f32 v149, v149, v237
    v_mul_f32 v150, v150, v238
    v_mul_f32 v151, v151, v239
    v_fmaak_f32 v232, v160, v160, 0x409d30fc
    v_fmaak_f32 v233, v161, v161, 0x409d30fc
    v_fmaak_f32 v234, v162, v162, 0x409d30fc
    v_fmaak_f32 v235, v163, v163, 0x409d30fc
    v_fmaak_f32 v236, v164, v164, 0x409d30fc
    v_fmaak_f32 v237, v165, v165, 0x409d30fc
    v_fmaak_f32 v238, v166, v166, 0x409d30fc
    v_fmaak_f32 v239, v167, v167, 0x409d30fc
    v_mul_f32 v232, v160, v232
    v_mul_f32 v233, v161, v233
    v_mul_f32 v234, v162, v234
    v_mul_f32 v235, v163, v235
    v_mul_f32 v236, v164, v236
    v_mul_f32 v237, v165, v237
    v_mul_f32 v238, v166, v238
    v_mul_f32 v239, v167, v239
    v_exp_f32_e64 v232, -v232
    v_exp_f32_e64 v233, -v233
    v_exp_f32_e64 v234, -v234
    v_exp_f32_e64 v235, -v235
    v_exp_f32_e64 v236, -v236
    v_exp_f32_e64 v237, -v237
    v_exp_f32_e64 v238, -v238
    v_exp_f32_e64 v239, -v239
    v_add_f32 v232, 1.0, v232
    v_add_f32 v233, 1.0, v233
    v_add_f32 v234, 1.0, v234
    v_add_f32 v235, 1.0, v235
    v_add_f32 v236, 1.0, v236
    v_add_f32 v237, 1.0, v237
    v_add_f32 v238, 1.0, v238
    v_add_f32 v239, 1.0, v239
    v_rcp_f32 v232, v232
    v_rcp_f32 v233, v233
    v_rcp_f32 v234, v234
    v_rcp_f32 v235, v235
    v_rcp_f32 v236, v236
    v_rcp_f32 v237, v237
    v_rcp_f32 v238, v238
    v_rcp_f32 v239, v239
    v_mul_f32 v160, v160, v232
    v_mul_f32 v161, v161, v233
    v_mul_f32 v162, v162, v234
    v_mul_f32 v163, v163, v235
    v_mul_f32 v164, v164, v236
    v_mul_f32 v165, v165, v237
    v_mul_f32 v166, v166, v238
    v_mul_f32 v167, v167, v239
    v_cvt_pk_bf16_f32 v240, v144, v160
    v_cvt_pk_bf16_f32 v241, v145, v161
    v_cvt_pk_bf16_f32 v242, v146, v162
    v_cvt_pk_bf16_f32 v243, v147, v163
    ds_write_b128 v11, v[240:243] offset:2048
    v_cvt_pk_bf16_f32 v244, v148, v164
    v_cvt_pk_bf16_f32 v245, v149, v165
    v_cvt_pk_bf16_f32 v246, v150, v166
    v_cvt_pk_bf16_f32 v247, v151, v167
    ds_write_b128 v11, v[244:247] offset:3072
    s_bitcmp1_b32 s69, 4
    s_cbranch_scc0 L_m_g2
    s_waitcnt lgkmcnt(0)
    s_barrier
L_m_g2:
    s_lshr_b32 s47, s40, 1
    s_lshl_b32 s47, s47, 12
    s_add_u32 s46, s46, s47
    s_and_b32 s47, s40, 1
    s_lshl_b32 s47, s47, 9
    s_add_u32 s46, s46, s47
    s_add_u32 s46, s46, 16384
    v_lshl_add_u32 v12, v10, 8, v9
    v_and_b32 v13, 1, v6
    v_lshl_add_u32 v12, v13, 3, v12
    v_add_u32 v12, s46, v12
    v_fmaak_f32 v232, v168, v168, 0x409d30fc
    v_fmaak_f32 v233, v169, v169, 0x409d30fc
    v_fmaak_f32 v234, v170, v170, 0x409d30fc
    v_fmaak_f32 v235, v171, v171, 0x409d30fc
    v_fmaak_f32 v236, v172, v172, 0x409d30fc
    v_fmaak_f32 v237, v173, v173, 0x409d30fc
    v_fmaak_f32 v238, v174, v174, 0x409d30fc
    v_fmaak_f32 v239, v175, v175, 0x409d30fc
    v_mul_f32 v232, v168, v232
    v_mul_f32 v233, v169, v233
    v_mul_f32 v234, v170, v234
    v_mul_f32 v235, v171, v235
    v_mul_f32 v236, v172, v236
    v_mul_f32 v237, v173, v237
    v_mul_f32 v238, v174, v238
    v_mul_f32 v239, v175, v239
    v_exp_f32_e64 v232, -v232
    v_exp_f32_e64 v233, -v233
    v_exp_f32_e64 v234, -v234
    v_exp_f32_e64 v235, -v235
    v_exp_f32_e64 v236, -v236
    v_exp_f32_e64 v237, -v237
    v_exp_f32_e64 v238, -v238
    v_exp_f32_e64 v239, -v239
    v_add_f32 v232, 1.0, v232
    v_add_f32 v233, 1.0, v233
    v_add_f32 v234, 1.0, v234
    v_add_f32 v235, 1.0, v235
    v_add_f32 v236, 1.0, v236
    v_add_f32 v237, 1.0, v237
    v_add_f32 v238, 1.0, v238
    v_add_f32 v239, 1.0, v239
    v_rcp_f32 v232, v232
    v_rcp_f32 v233, v233
    v_rcp_f32 v234, v234
    v_rcp_f32 v235, v235
    v_rcp_f32 v236, v236
    v_rcp_f32 v237, v237
    v_rcp_f32 v238, v238
    v_rcp_f32 v239, v239
    v_mul_f32 v168, v168, v232
    v_mul_f32 v169, v169, v233
    v_mul_f32 v170, v170, v234
    v_mul_f32 v171, v171, v235
    v_mul_f32 v172, v172, v236
    v_mul_f32 v173, v173, v237
    v_mul_f32 v174, v174, v238
    v_mul_f32 v175, v175, v239
    v_cvt_pk_bf16_f32 v248, v168, v169
    v_cvt_pk_bf16_f32 v249, v170, v171
    ds_write_b64 v12, v[248:249] offset:0
    v_cvt_pk_bf16_f32 v250, v172, v173
    v_cvt_pk_bf16_f32 v251, v174, v175
    ds_write_b64 v12, v[250:251] offset:1024
    v_fmaak_f32 v232, v176, v176, 0x409d30fc
    v_fmaak_f32 v233, v177, v177, 0x409d30fc
    v_fmaak_f32 v234, v178, v178, 0x409d30fc
    v_fmaak_f32 v235, v179, v179, 0x409d30fc
    v_fmaak_f32 v236, v180, v180, 0x409d30fc
    v_fmaak_f32 v237, v181, v181, 0x409d30fc
    v_fmaak_f32 v238, v182, v182, 0x409d30fc
    v_fmaak_f32 v239, v183, v183, 0x409d30fc
    v_mul_f32 v232, v176, v232
    v_mul_f32 v233, v177, v233
    v_mul_f32 v234, v178, v234
    v_mul_f32 v235, v179, v235
    v_mul_f32 v236, v180, v236
    v_mul_f32 v237, v181, v237
    v_mul_f32 v238, v182, v238
    v_mul_f32 v239, v183, v239
    v_exp_f32_e64 v232, -v232
    v_exp_f32_e64 v233, -v233
    v_exp_f32_e64 v234, -v234
    v_exp_f32_e64 v235, -v235
    v_exp_f32_e64 v236, -v236
    v_exp_f32_e64 v237, -v237
    v_exp_f32_e64 v238, -v238
    v_exp_f32_e64 v239, -v239
    v_add_f32 v232, 1.0, v232
    v_add_f32 v233, 1.0, v233
    v_add_f32 v234, 1.0, v234
    v_add_f32 v235, 1.0, v235
    v_add_f32 v236, 1.0, v236
    v_add_f32 v237, 1.0, v237
    v_add_f32 v238, 1.0, v238
    v_add_f32 v239, 1.0, v239
    v_rcp_f32 v232, v232
    v_rcp_f32 v233, v233
    v_rcp_f32 v234, v234
    v_rcp_f32 v235, v235
    v_rcp_f32 v236, v236
    v_rcp_f32 v237, v237
    v_rcp_f32 v238, v238
    v_rcp_f32 v239, v239
    v_mul_f32 v176, v176, v232
    v_mul_f32 v177, v177, v233
    v_mul_f32 v178, v178, v234
    v_mul_f32 v179, v179, v235
    v_mul_f32 v180, v180, v236
    v_mul_f32 v181, v181, v237
    v_mul_f32 v182, v182, v238
    v_mul_f32 v183, v183, v239
    v_cvt_pk_bf16_f32 v248, v176, v177
    v_cvt_pk_bf16_f32 v249, v178, v179
    ds_write_b64 v12, v[248:249] offset:2048
    v_cvt_pk_bf16_f32 v250, v180, v181
    v_cvt_pk_bf16_f32 v251, v182, v183
    ds_write_b64 v12, v[250:251] offset:3072
    s_setpc_b64 s[74:75]
L_m_cvt:
    v_cvt_pk_bf16_f32 v232, v136, v152
    v_cvt_pk_bf16_f32 v233, v137, v153
    v_cvt_pk_bf16_f32 v234, v138, v154
    v_cvt_pk_bf16_f32 v235, v139, v155
    v_cvt_pk_bf16_f32 v248, v168, v169
    v_cvt_pk_bf16_f32 v249, v170, v171
    v_cvt_pk_bf16_f32 v236, v140, v156
    v_cvt_pk_bf16_f32 v237, v141, v157
    v_cvt_pk_bf16_f32 v238, v142, v158
    v_cvt_pk_bf16_f32 v239, v143, v159
    v_cvt_pk_bf16_f32 v250, v172, v173
    v_cvt_pk_bf16_f32 v251, v174, v175
    v_cvt_pk_bf16_f32 v240, v144, v160
    v_cvt_pk_bf16_f32 v241, v145, v161
    v_cvt_pk_bf16_f32 v242, v146, v162
    v_cvt_pk_bf16_f32 v243, v147, v163
    v_cvt_pk_bf16_f32 v252, v176, v177
    v_cvt_pk_bf16_f32 v253, v178, v179
    v_cvt_pk_bf16_f32 v244, v148, v164
    v_cvt_pk_bf16_f32 v245, v149, v165
    v_cvt_pk_bf16_f32 v246, v150, v166
    v_cvt_pk_bf16_f32 v247, v151, v167
    v_cvt_pk_bf16_f32 v254, v180, v181
    v_cvt_pk_bf16_f32 v255, v182, v183
    v_permlane16_swap_b32 v248, v250
    v_permlane16_swap_b32 v249, v251
    v_permlane16_swap_b32 v252, v254
    v_permlane16_swap_b32 v253, v255
    s_setpc_b64 s[74:75]
L_m_st:
    s_mul_i32 s45, s68, 3072
    s_add_u32 s46, s45, s71
    v_bfe_u32 v13, v1, 3, 1
    s_mov_b32 s47, 73728
    v_mul_lo_u32 v11, v13, s47
    v_sub_u32 v11, v14, v11
    v_add_u32 v11, s45, v11
    v_bfe_u32 v7, v1, 3, 2
    v_mul_lo_u32 v12, v7, s47
    v_sub_u32 v12, v15, v12
    v_add_u32 v12, s45, v12
    s_add_u32 s47, s46, 0
    s_sub_u32 s45, s43, 0
    v_cmp_ne_u32 vcc, s45, v13
    s_nop 0
    s_mov_b64 exec, vcc
    buffer_store_dwordx4 v[232:235], v14, s[32:35], s47 offen offset:0 sc1
    s_not_b64 exec, exec
    ds_write_b128 v11, v[232:235] offset:0
    s_mov_b64 exec, -1
    s_sub_u32 s45, s43, 0
    v_cmp_ne_u32 vcc, s45, v7
    s_nop 0
    s_mov_b64 exec, vcc
    buffer_store_dwordx4 v[248:251], v15, s[32:35], s47 offen offset:2048 sc1
    s_not_b64 exec, exec
    ds_write_b128 v12, v[248:251] offset:2048
    s_mov_b64 exec, -1
    s_add_u32 s47, s46, 147456
    s_sub_u32 s45, s43, 2
    v_cmp_ne_u32 vcc, s45, v13
    s_nop 0
    s_mov_b64 exec, vcc
    buffer_store_dwordx4 v[236:239], v14, s[32:35], s47 offen offset:0 sc1
    s_not_b64 exec, exec
    ds_write_b128 v11, v[236:239] offset:0
    s_mov_b64 exec, -1
    s_add_u32 s47, s46, 294912
    s_sub_u32 s45, s43, 4
    v_cmp_ne_u32 vcc, s45, v13
    s_nop 0
    s_mov_b64 exec, vcc
    buffer_store_dwordx4 v[240:243], v14, s[32:35], s47 offen offset:0 sc1
    s_not_b64 exec, exec
    ds_write_b128 v11, v[240:243] offset:0
    s_mov_b64 exec, -1
    s_sub_u32 s45, s43, 4
    v_cmp_ne_u32 vcc, s45, v7
    s_nop 0
    s_mov_b64 exec, vcc
    buffer_store_dwordx4 v[252:255], v15, s[32:35], s47 offen offset:2048 sc1
    s_not_b64 exec, exec
    ds_write_b128 v12, v[252:255] offset:2048
    s_mov_b64 exec, -1
    s_add_u32 s47, s46, 442368
    s_sub_u32 s45, s43, 6
    v_cmp_ne_u32 vcc, s45, v13
    s_nop 0
    s_mov_b64 exec, vcc
    buffer_store_dwordx4 v[244:247], v14, s[32:35], s47 offen offset:0 sc1
    s_not_b64 exec, exec
    ds_write_b128 v11, v[244:247] offset:0
    s_mov_b64 exec, -1
    s_nop 1
    s_setpc_b64 s[74:75]
L_r_init:
    v_lshrrev_b32 v11, 3, v1
    v_lshlrev_b32 v11, 4, v11
    s_lshl_b32 s45, s48, 7
    buffer_load_dwordx4 v[168:171], v11, s[36:39], s45 offen
    s_mul_i32 s72, s57, 73728
    s_lshl_b32 s47, s48, 10
    s_add_u32 s72, s72, s47
    s_add_u32 s72, s72, 16908288
    s_add_u32 s47, s47, 152064
    v_add_u32 v12, s47, v2
    ds_read_b128 v[172:175], v12
    v_mad_u32_u24 v198, v5, s44, v11
    s_mul_i32 s73, s57, 9216
    s_add_u32 s73, s73, s45
    s_setpc_b64 s[74:75]
L_r_item:
    s_lshl_b32 s47, s48, 10
    v_add_u32 v12, s47, v2
    ds_read_b128 v[164:167], v12
    s_add_u32 s46, s43, 1
    s_and_b32 s46, s46, 7
    s_mul_i32 s46, s46, 9216
    s_add_u32 s46, s46, s72
    buffer_load_dwordx4 v[136:139], v2, s[32:35], s46 offen sc1
    s_add_u32 s46, s43, 2
    s_and_b32 s46, s46, 7
    s_mul_i32 s46, s46, 9216
    s_add_u32 s46, s46, s72
    buffer_load_dwordx4 v[140:143], v2, s[32:35], s46 offen sc1
    s_add_u32 s46, s43, 3
    s_and_b32 s46, s46, 7
    s_mul_i32 s46, s46, 9216
    s_add_u32 s46, s46, s72
    buffer_load_dwordx4 v[144:147], v2, s[32:35], s46 offen sc1
    s_add_u32 s46, s43, 4
    s_and_b32 s46, s46, 7
    s_mul_i32 s46, s46, 9216
    s_add_u32 s46, s46, s72
    buffer_load_dwordx4 v[148:151], v2, s[32:35], s46 offen sc1
    s_add_u32 s46, s43, 5
    s_and_b32 s46, s46, 7
    s_mul_i32 s46, s46, 9216
    s_add_u32 s46, s46, s72
    buffer_load_dwordx4 v[152:155], v2, s[32:35], s46 offen sc1
    s_add_u32 s46, s43, 6
    s_and_b32 s46, s46, 7
    s_mul_i32 s46, s46, 9216
    s_add_u32 s46, s46, s72
    buffer_load_dwordx4 v[156:159], v2, s[32:35], s46 offen sc1
    s_add_u32 s46, s43, 7
    s_and_b32 s46, s46, 7
    s_mul_i32 s46, s46, 9216
    s_add_u32 s46, s46, s72
    buffer_load_dwordx4 v[160:163], v2, s[32:35], s46 offen sc1
    s_waitcnt lgkmcnt(0)
    v_lshlrev_b32 v184, 16, v172
    v_and_b32 v185, s76, v172
    v_lshlrev_b32 v186, 16, v173
    v_and_b32 v187, s76, v173
    v_lshlrev_b32 v188, 16, v174
    v_and_b32 v189, s76, v174
    v_lshlrev_b32 v190, 16, v175
    v_and_b32 v191, s76, v175
    s_waitcnt vmcnt(7)
    v_lshlrev_b32 v196, 16, v168
    v_and_b32 v197, s76, v168
    v_add_f32 v184, v184, v196
    v_add_f32 v185, v185, v197
    v_lshlrev_b32 v196, 16, v169
    v_and_b32 v197, s76, v169
    v_add_f32 v186, v186, v196
    v_add_f32 v187, v187, v197
    v_lshlrev_b32 v196, 16, v170
    v_and_b32 v197, s76, v170
    v_add_f32 v188, v188, v196
    v_add_f32 v189, v189, v197
    v_lshlrev_b32 v196, 16, v171
    v_and_b32 v197, s76, v171
    v_add_f32 v190, v190, v196
    v_add_f32 v191, v191, v197
    s_waitcnt vmcnt(7)
    v_lshlrev_b32 v196, 16, v164
    v_and_b32 v197, s76, v164
    v_fmac_f32 v184, s77, v196
    v_fmac_f32 v185, s77, v197
    v_lshlrev_b32 v196, 16, v165
    v_and_b32 v197, s76, v165
    v_fmac_f32 v186, s77, v196
    v_fmac_f32 v187, s77, v197
    v_lshlrev_b32 v196, 16, v166
    v_and_b32 v197, s76, v166
    v_fmac_f32 v188, s77, v196
    v_fmac_f32 v189, s77, v197
    v_lshlrev_b32 v196, 16, v167
    v_and_b32 v197, s76, v167
    v_fmac_f32 v190, s77, v196
    v_fmac_f32 v191, s77, v197
    s_waitcnt vmcnt(6)
    buffer_load_dword v7, v8, s[32:35], s52 offen sc1
    v_lshlrev_b32 v196, 16, v136
    v_and_b32 v197, s76, v136
    v_fmac_f32 v184, s77, v196
    v_fmac_f32 v185, s77, v197
    v_lshlrev_b32 v196, 16, v137
    v_and_b32 v197, s76, v137
    v_fmac_f32 v186, s77, v196
    v_fmac_f32 v187, s77, v197
    v_lshlrev_b32 v196, 16, v138
    v_and_b32 v197, s76, v138
    v_fmac_f32 v188, s77, v196
    v_fmac_f32 v189, s77, v197
    v_lshlrev_b32 v196, 16, v139
    v_and_b32 v197, s76, v139
    v_fmac_f32 v190, s77, v196
    v_fmac_f32 v191, s77, v197
    s_waitcnt vmcnt(6)
    v_lshlrev_b32 v196, 16, v140
    v_and_b32 v197, s76, v140
    v_fmac_f32 v184, s77, v196
    v_fmac_f32 v185, s77, v197
    v_lshlrev_b32 v196, 16, v141
    v_and_b32 v197, s76, v141
    v_fmac_f32 v186, s77, v196
    v_fmac_f32 v187, s77, v197
    v_lshlrev_b32 v196, 16, v142
    v_and_b32 v197, s76, v142
    v_fmac_f32 v188, s77, v196
    v_fmac_f32 v189, s77, v197
    v_lshlrev_b32 v196, 16, v143
    v_and_b32 v197, s76, v143
    v_fmac_f32 v190, s77, v196
    v_fmac_f32 v191, s77, v197
    s_waitcnt vmcnt(5)
    v_lshlrev_b32 v196, 16, v144
    v_and_b32 v197, s76, v144
    v_fmac_f32 v184, s77, v196
    v_fmac_f32 v185, s77, v197
    v_lshlrev_b32 v196, 16, v145
    v_and_b32 v197, s76, v145
    v_fmac_f32 v186, s77, v196
    v_fmac_f32 v187, s77, v197
    v_lshlrev_b32 v196, 16, v146
    v_and_b32 v197, s76, v146
    v_fmac_f32 v188, s77, v196
    v_fmac_f32 v189, s77, v197
    v_lshlrev_b32 v196, 16, v147
    v_and_b32 v197, s76, v147
    v_fmac_f32 v190, s77, v196
    v_fmac_f32 v191, s77, v197
    s_waitcnt vmcnt(4)
    v_lshlrev_b32 v196, 16, v148
    v_and_b32 v197, s76, v148
    v_fmac_f32 v184, s77, v196
    v_fmac_f32 v185, s77, v197
    v_lshlrev_b32 v196, 16, v149
    v_and_b32 v197, s76, v149
    v_fmac_f32 v186, s77, v196
    v_fmac_f32 v187, s77, v197
    v_lshlrev_b32 v196, 16, v150
    v_and_b32 v197, s76, v150
    v_fmac_f32 v188, s77, v196
    v_fmac_f32 v189, s77, v197
    v_lshlrev_b32 v196, 16, v151
    v_and_b32 v197, s76, v151
    v_fmac_f32 v190, s77, v196
    v_fmac_f32 v191, s77, v197
    s_waitcnt vmcnt(3)
    v_lshlrev_b32 v196, 16, v152
    v_and_b32 v197, s76, v152
    v_fmac_f32 v184, s77, v196
    v_fmac_f32 v185, s77, v197
    v_lshlrev_b32 v196, 16, v153
    v_and_b32 v197, s76, v153
    v_fmac_f32 v186, s77, v196
    v_fmac_f32 v187, s77, v197
    v_lshlrev_b32 v196, 16, v154
    v_and_b32 v197, s76, v154
    v_fmac_f32 v188, s77, v196
    v_fmac_f32 v189, s77, v197
    v_lshlrev_b32 v196, 16, v155
    v_and_b32 v197, s76, v155
    v_fmac_f32 v190, s77, v196
    v_fmac_f32 v191, s77, v197
    s_waitcnt vmcnt(2)
    v_lshlrev_b32 v196, 16, v156
    v_and_b32 v197, s76, v156
    v_fmac_f32 v184, s77, v196
    v_fmac_f32 v185, s77, v197
    v_lshlrev_b32 v196, 16, v157
    v_and_b32 v197, s76, v157
    v_fmac_f32 v186, s77, v196
    v_fmac_f32 v187, s77, v197
    v_lshlrev_b32 v196, 16, v158
    v_and_b32 v197, s76, v158
    v_fmac_f32 v188, s77, v196
    v_fmac_f32 v189, s77, v197
    v_lshlrev_b32 v196, 16, v159
    v_and_b32 v197, s76, v159
    v_fmac_f32 v190, s77, v196
    v_fmac_f32 v191, s77, v197
    s_waitcnt vmcnt(1)
    v_lshlrev_b32 v196, 16, v160
    v_and_b32 v197, s76, v160
    v_fmac_f32 v184, s77, v196
    v_fmac_f32 v185, s77, v197
    v_lshlrev_b32 v196, 16, v161
    v_and_b32 v197, s76, v161
    v_fmac_f32 v186, s77, v196
    v_fmac_f32 v187, s77, v197
    v_lshlrev_b32 v196, 16, v162
    v_and_b32 v197, s76, v162
    v_fmac_f32 v188, s77, v196
    v_fmac_f32 v189, s77, v197
    v_lshlrev_b32 v196, 16, v163
    v_and_b32 v197, s76, v163
    v_fmac_f32 v190, s77, v196
    v_fmac_f32 v191, s77, v197
    v_cvt_pk_bf16_f32 v192, v184, v185
    v_cvt_pk_bf16_f32 v193, v186, v187
    v_cvt_pk_bf16_f32 v194, v188, v189
    v_cvt_pk_bf16_f32 v195, v190, v191
    buffer_store_dwordx4 v[192:195], v198, s[24:27], s73 offen
    s_nop 1
    s_setpc_b64 s[74:75]
.section .rodata,"a"
.p2align 6
.amdhsa_kernel sequential_preLN__grouped_kv_mqa__mixer_channel_mlp__prompt_kernel
  .amdhsa_next_free_vgpr 256
  .amdhsa_next_free_sgpr 80
  .amdhsa_accum_offset 256
  .amdhsa_group_segment_fixed_size 0
  .amdhsa_kernarg_size 104
  .amdhsa_user_sgpr_count 2
  .amdhsa_user_sgpr_kernarg_segment_ptr 1
  .amdhsa_system_sgpr_workgroup_id_x 1
.end_amdhsa_kernel
```
